```python
import torch

def _softmax(x, axis=-1):
    return torch.softmax(x, dim=axis)
def _gelu(x):
    return torch.nn.functional.gelu(x, approximate="tanh")
def _silu(x):
    return torch.nn.functional.silu(x)
def _sigmoid(x):
    return torch.sigmoid(x)
def _layernorm(x, axis=-1, eps=1e-5):
    m = x.mean(dim=axis, keepdim=True)
    v = x.var(dim=axis, keepdim=True, unbiased=False)
    return (x - m) / torch.sqrt(v + eps)
def _scatter_add(tgt, idx, src, axis=0):
    return tgt.clone().index_add_(axis, idx, src)
def _segment_sum(src, seg, n):
    out = torch.zeros((n,) + src.shape[1:], dtype=src.dtype)
    return out.index_add_(0, seg, src)
def _pad(x, pw):
    flat = tuple(v for pair in reversed(pw) for v in pair)
    return torch.nn.functional.pad(x, flat)

kernel_name = 'gated_mix__sliding_block_cached__sliding_block_cached__decode'

def setup_inputs():

    _w = (lambda a: (lambda t: t.to(torch.bfloat16) if t.is_floating_point() else t)(torch.as_tensor(a)))
    def _A_setup():
        B, Sq, D = 8, 1, 448
        Hq, Hkv, Sk, Dh = 16, 8, 4096, 256
        assert Hq % Hkv == 0, (Hq, Hkv)
        return {
            "x": _w((lambda *s: torch.randn(*s, dtype=torch.bfloat16) * 0.05)(B, Sq, D)),
            "k_cache": _w((lambda *s: torch.randn(*s, dtype=torch.bfloat16) * 3.2)(B, Hkv, Sk, Dh)),
            "v_cache": _w((lambda *s: torch.randn(*s, dtype=torch.bfloat16) * 0.05)(B, Hkv, Sk, Dh)),
            "wq": _w((lambda *s: torch.randn(*s, dtype=torch.bfloat16) * 3.2)(D, Hq * Dh) * (D ** -0.5)),
            "wo": _w((lambda *s: torch.randn(*s, dtype=torch.bfloat16) * 0.05)(Hq * Dh, D) * ((Hq * Dh) ** -0.5)),
        }
    _A_in = _A_setup()

    def _B_setup():
        B, Sq, D = 8, 1, 448
        Hq, Hkv, Sk, Dh = 16, 8, 4096, 256
        assert Hq % Hkv == 0, (Hq, Hkv)
        return {
            "x": _w((lambda *s: torch.randn(*s, dtype=torch.bfloat16) * 0.05)(B, Sq, D)),
            "k_cache": _w((lambda *s: torch.randn(*s, dtype=torch.bfloat16) * 3.2)(B, Hkv, Sk, Dh)),
            "v_cache": _w((lambda *s: torch.randn(*s, dtype=torch.bfloat16) * 0.05)(B, Hkv, Sk, Dh)),
            "wq": _w((lambda *s: torch.randn(*s, dtype=torch.bfloat16) * 3.2)(D, Hq * Dh) * (D ** -0.5)),
            "wo": _w((lambda *s: torch.randn(*s, dtype=torch.bfloat16) * 0.05)(Hq * Dh, D) * ((Hq * Dh) ** -0.5)),
        }
    _B_in = _B_setup()

    return {
        "A_x": _A_in["x"],
        "A_k_cache": _A_in["k_cache"],
        "A_v_cache": _A_in["v_cache"],
        "A_wq": _A_in["wq"],
        "A_wo": _A_in["wo"],
        "B_x": _B_in["x"],
        "B_k_cache": _B_in["k_cache"],
        "B_v_cache": _B_in["v_cache"],
        "B_wq": _B_in["wq"],
        "B_wo": _B_in["wo"],
        "gate_w": _w((lambda *s: torch.randn(*s, dtype=torch.bfloat16) * 0.05)(448) * 16.0),
    }

def reference(A_x, A_k_cache, A_v_cache, A_wq, A_wo, B_x, B_k_cache, B_v_cache, B_wq, B_wo, gate_w):
    def _A_ref(x, k_cache, v_cache, wq, wo):
        B, Sq, D = x.shape
        Hq, Dh = 16, 256
        Hkv, Sk = k_cache.shape[1], k_cache.shape[2]
        W = min(4096, max(256, Sk // 4))
        rep = Hq // Hkv
        q = (lambda x, *d: x.permute(*d))((x @ wq).reshape(B, Sq, Hq, Dh), 0, 2, 1, 3)
        k = (lambda x, n, axis: torch.repeat_interleave(x, n, dim=axis))(k_cache[:, :, Sk - W:, :], rep, axis=1)
        v = (lambda x, n, axis: torch.repeat_interleave(x, n, dim=axis))(v_cache[:, :, Sk - W:, :], rep, axis=1)
        scores = torch.einsum("bhqd,bhkd->bhqk", q, k) * (Dh ** -0.5)
        p = _softmax(scores, axis=-1)
        o = torch.einsum("bhqk,bhkd->bhqd", p, v)
        return (lambda x, *d: x.permute(*d))(o, 0, 2, 1, 3).reshape(B, Sq, Hq * Dh) @ wo

    def _B_ref(x, k_cache, v_cache, wq, wo):
        B, Sq, D = x.shape
        Hq, Dh = 16, 256
        Hkv, Sk = k_cache.shape[1], k_cache.shape[2]
        W = min(4096, max(256, Sk // 4))
        rep = Hq // Hkv
        q = (lambda x, *d: x.permute(*d))((x @ wq).reshape(B, Sq, Hq, Dh), 0, 2, 1, 3)
        k = (lambda x, n, axis: torch.repeat_interleave(x, n, dim=axis))(k_cache[:, :, Sk - W:, :], rep, axis=1)
        v = (lambda x, n, axis: torch.repeat_interleave(x, n, dim=axis))(v_cache[:, :, Sk - W:, :], rep, axis=1)
        scores = torch.einsum("bhqd,bhkd->bhqk", q, k) * (Dh ** -0.5)
        p = _softmax(scores, axis=-1)
        o = torch.einsum("bhqk,bhkd->bhqd", p, v)
        return (lambda x, *d: x.permute(*d))(o, 0, 2, 1, 3).reshape(B, Sq, Hq * Dh) @ wo

    x = A_x
    g = _sigmoid((x * gate_w).sum(-1, keepdims=True))
    a = _A_ref(x, A_k_cache, A_v_cache, A_wq, A_wo)
    b = _B_ref(x, B_k_cache, B_v_cache, B_wq, B_wo)
    return g * a + (1 - g) * b
```

```asm
; @launch grid=(256,1,1) block=(512,1,1) lds=98304
.amdgcn_target "amdgcn-amd-amdhsa--gfx950"
.text
.globl gated_mix__sliding_block_cached__sliding_block_cached__decode_kernel
.p2align 8
.type gated_mix__sliding_block_cached__sliding_block_cached__decode_kernel,@function
gated_mix__sliding_block_cached__sliding_block_cached__decode_kernel:
    s_cmp_ge_u32 s2, 256
    s_cbranch_scc1 L_end
    s_lshr_b32 s57, s2, 7
    s_mul_i32 s3, s57, 40
    s_add_u32 s4, s0, s3
    s_addc_u32 s5, s1, 0
    s_load_dwordx8 s[8:15], s[4:5], 8
    s_load_dwordx2 s[28:29], s[0:1], 104
    s_load_dwordx2 s[36:37], s[0:1], 0
    s_load_dwordx4 s[48:51], s[0:1], 80
    v_lshrrev_b32 v6, 6, v0
    v_and_b32 v1, 63, v0
    v_readfirstlane_b32 s54, v6
    v_and_b32 v2, 15, v1
    v_lshrrev_b32 v3, 4, v1
    v_and_b32 v15, 3, v1
    v_lshlrev_b32 v60, 4, v2
    s_and_b32 s55, s2, 7
    s_bfe_u32 s56, s2, 0x40003
    s_cmp_lt_u32 s54, 4
    s_cbranch_scc1 L_stream0
    s_sub_u32 s79, s54, 4
    s_mov_b32 s93, s55
    s_mov_b32 s88, s56
    s_lshl_b32 s7, s93, 10
    s_lshl_b32 s59, s88, 6
    s_add_u32 s7, s7, s59
    s_mov_b32 s35, 0x20000
    s_sub_u32 s34, 3670016, s7
    s_mul_i32 s80, s79, 917504
    s_add_u32 s81, s80, 130048
    s_add_u32 s82, s80, 260096
    s_add_u32 s83, s80, 390144
    s_mul_i32 s59, s79, 7168
    s_add_u32 m0, s59, 0
    v_lshrrev_b32 v6, 2, v1
    v_lshlrev_b32 v6, 13, v6
    v_lshl_add_u32 v6, v15, 4, v6
    s_waitcnt lgkmcnt(0)
    s_add_u32 s32, s12, s7
    s_addc_u32 s33, s13, 0
    buffer_load_dwordx4 v6, s[32:35], s80 offen offset:0 nt lds
    buffer_load_dwordx4 v6, s[32:35], s81 offen offset:1024 nt lds
    buffer_load_dwordx4 v6, s[32:35], s82 offen offset:2048 nt lds
    buffer_load_dwordx4 v6, s[32:35], s83 offen offset:3072 nt lds
    s_add_u32 m0, m0, 4096
    s_add_u32 s84, s80, 524288
    s_add_u32 s85, s80, 654336
    s_add_u32 s86, s80, 784384
    buffer_load_dwordx4 v6, s[32:35], s84 offen offset:0 nt lds
    buffer_load_dwordx4 v6, s[32:35], s85 offen offset:1024 nt lds
    buffer_load_dwordx4 v6, s[32:35], s86 offen offset:2048 nt lds
    s_mov_b32 s38, 7168
    s_mov_b32 s39, 0x20000
    s_mul_i32 s68, s79, 224
    s_add_u32 s69, s68, 2560
    s_lshl_b32 s87, s79, 11
    s_add_u32 s87, s87, 65536
    s_mov_b32 m0, s87
    v_mul_u32_u24 v7, 896, v3
    v_add_u32 v7, v7, v60
    buffer_load_dwordx4 v7, s[36:39], s68 offen lds
    buffer_load_dwordx4 v7, s[36:39], s69 offen offset:1024 lds
    s_lshl_b32 s3, s79, 2
    s_add_u32 s3, s3, 64640
    v_mov_b32 v9, s3
    v_mov_b32 v8, 0
    ds_write_b32 v9, v8
    s_waitcnt lgkmcnt(0)
    s_barrier
    s_add_u32 s94, s28, 2031616
    s_addc_u32 s95, s29, 0
    s_load_dwordx2 s[52:53], s[94:95], 0
    s_lshl_b32 s58, s57, 3
    s_add_u32 s58, s58, s55
    s_and_b32 s75, s56, 7
    s_lshr_b32 s71, s56, 3
    s_lshl_b32 s3, s75, 24
    s_lshl_b32 s6, s55, 21
    s_add_u32 s6, s6, s3
    s_lshl_b32 s3, s71, 18
    s_add_u32 s6, s6, s3
    s_add_u32 s6, s6, 0x180000
    s_mul_i32 s60, s54, 2
    s_mul_i32 s3, s75, 3
    s_add_u32 s60, s60, s3
    s_mul_i32 s3, s55, 1
    s_add_u32 s60, s60, s3
    s_mul_i32 s3, s71, 4
    s_add_u32 s60, s60, s3
    s_mul_i32 s3, s57, 2
    s_add_u32 s60, s60, s3
    s_lshl_b32 s60, s60, 12
    s_and_b32 s60, s60, 0x7fff
    s_add_u32 s61, s60, 4096
    s_and_b32 s61, s61, 0x7fff
    s_add_u32 s62, s61, 4096
    s_and_b32 s62, s62, 0x7fff
    s_add_u32 s63, s62, 4096
    s_and_b32 s63, s63, 0x7fff
    s_add_u32 s64, s63, 4096
    s_and_b32 s64, s64, 0x7fff
    s_add_u32 s65, s64, 4096
    s_and_b32 s65, s65, 0x7fff
    s_add_u32 s66, s65, 4096
    s_and_b32 s66, s66, 0x7fff
    s_add_u32 s67, s66, 4096
    s_and_b32 s67, s67, 0x7fff
    s_mov_b32 s70, 200000
    s_lshl_b32 s3, s54, 15
    v_lshrrev_b32 v5, 2, v2
    v_lshlrev_b32 v4, 9, v5
    v_lshl_add_u32 v4, v15, 4, v4
    v_lshl_add_u32 v4, v3, 6, v4
    v_add_u32 v4, s3, v4
    v_lshl_add_u32 v5, v3, 9, v60
    v_add_u32 v5, s3, v5
    v_lshlrev_b32 v12, 4, v1
    s_mov_b32 s30, 8388608
    s_mov_b32 s31, 0x20000
    s_mov_b32 s22, 0x40000
    s_mov_b32 s23, 0x20000
    s_mov_b32 s26, 0x40000
    s_mov_b32 s27, 0x20000
    s_add_u32 s20, s8, s6
    s_addc_u32 s21, s9, 0
    s_add_u32 s24, s10, s6
    s_addc_u32 s25, s11, 0
    v_mul_u32_u24 v14, 28, v3
    v_lshrrev_b32 v8, 2, v2
    v_add_u32 v14, v14, v8
    v_lshlrev_b32 v14, 6, v14
    v_lshl_add_u32 v14, v15, 3, v14
    v_add_u32 v14, s59, v14
    s_lshl_b32 s3, s79, 11
    v_add_u32 v13, s3, v12
    v_and_b32 v7, 7, v2
    v_lshlrev_b32 v7, 8, v7
    v_mul_u32_u24 v8, 56, v3
    v_add3_u32 v7, v7, v8, s87
    s_waitcnt vmcnt(0) lgkmcnt(0)
    ds_read_b64 v[64:65], v7 offset:0
    ds_read_b64 v[66:67], v7 offset:8
    ds_read_b64 v[68:69], v7 offset:16
    ds_read_b64 v[70:71], v7 offset:24
    ds_read_b64 v[72:73], v7 offset:32
    ds_read_b64 v[74:75], v7 offset:40
    ds_read_b64 v[76:77], v7 offset:48
    s_waitcnt lgkmcnt(0)
    ds_read_b64_tr_b16 v[80:81], v14 offset:0
    ds_read_b64_tr_b16 v[82:83], v14 offset:32
    ds_read_b64_tr_b16 v[84:85], v14 offset:256
    ds_read_b64_tr_b16 v[86:87], v14 offset:288
    ds_read_b64_tr_b16 v[88:89], v14 offset:512
    ds_read_b64_tr_b16 v[90:91], v14 offset:544
    ds_read_b64_tr_b16 v[92:93], v14 offset:768
    ds_read_b64_tr_b16 v[94:95], v14 offset:800
    ds_read_b64_tr_b16 v[96:97], v14 offset:1024
    ds_read_b64_tr_b16 v[98:99], v14 offset:1056
    ds_read_b64_tr_b16 v[100:101], v14 offset:1280
    ds_read_b64_tr_b16 v[102:103], v14 offset:1312
    ds_read_b64_tr_b16 v[104:105], v14 offset:1536
    ds_read_b64_tr_b16 v[106:107], v14 offset:1568
    s_add_u32 s52, s52, 0x7f4a7c15
    s_addc_u32 s53, s53, 0x9e3779b9
    s_waitcnt lgkmcnt(12)
    v_mfma_f32_16x16x16_bf16 v[48:51], v[80:81], v[64:65], 0
    v_mfma_f32_16x16x16_bf16 v[52:55], v[82:83], v[64:65], 0
    s_waitcnt lgkmcnt(10)
    v_mfma_f32_16x16x16_bf16 v[48:51], v[84:85], v[66:67], v[48:51]
    v_mfma_f32_16x16x16_bf16 v[52:55], v[86:87], v[66:67], v[52:55]
    s_waitcnt lgkmcnt(8)
    v_mfma_f32_16x16x16_bf16 v[48:51], v[88:89], v[68:69], v[48:51]
    v_mfma_f32_16x16x16_bf16 v[52:55], v[90:91], v[68:69], v[52:55]
    s_waitcnt lgkmcnt(6)
    v_mfma_f32_16x16x16_bf16 v[48:51], v[92:93], v[70:71], v[48:51]
    v_mfma_f32_16x16x16_bf16 v[52:55], v[94:95], v[70:71], v[52:55]
    s_waitcnt lgkmcnt(4)
    v_mfma_f32_16x16x16_bf16 v[48:51], v[96:97], v[72:73], v[48:51]
    v_mfma_f32_16x16x16_bf16 v[52:55], v[98:99], v[72:73], v[52:55]
    s_waitcnt lgkmcnt(2)
    v_mfma_f32_16x16x16_bf16 v[48:51], v[100:101], v[74:75], v[48:51]
    v_mfma_f32_16x16x16_bf16 v[52:55], v[102:103], v[74:75], v[52:55]
    s_waitcnt lgkmcnt(0)
    v_mfma_f32_16x16x16_bf16 v[48:51], v[104:105], v[76:77], v[48:51]
    v_mfma_f32_16x16x16_bf16 v[52:55], v[106:107], v[76:77], v[52:55]
    v_mov_b32 v10, s52
    v_mov_b32 v11, s53
    v_mov_b32 v8, 1
    s_nop 3
    ds_write_b128 v13, v[48:51] offset:28672
    ds_write_b128 v13, v[52:55] offset:29696
    s_cmp_eq_u32 s54, 7
    s_waitcnt lgkmcnt(0)
    s_cbranch_scc1 L_w7
    s_mov_b64 exec, 1
    ds_write_b32 v9, v8
    s_mov_b64 exec, -1
    s_branch L_kloads
L_w7:
    s_setprio 3
    v_lshrrev_b32 v7, 3, v2
    v_lshl_add_u32 v13, v7, 10, v12
    v_mov_b32 v9, 64640
    s_lshl_b32 s74, s58, 14
    s_add_u32 s74, s74, 65536
    s_lshl_b32 s69, s75, 11
    s_add_u32 s74, s74, s69
    v_and_b32 v6, 7, v2
    v_lshlrev_b32 v6, 11, v6
    v_lshl_add_u32 v6, v7, 6, v6
    v_lshl_add_u32 v6, v3, 4, v6
    s_lshl_b32 s3, s57, 3
    s_add_u32 s3, s3, s93
    s_lshl_b32 s3, s3, 14
    s_add_u32 s3, s3, 65536
    s_lshl_b32 s69, s88, 7
    s_add_u32 s100, s3, s69
    s_getreg_b32 s96, hwreg(HW_REG_XCC_ID, 0, 4)
    s_and_b32 s97, s52, -16
    s_or_b32 s96, s96, s97
    v_mov_b32 v10, s96
    s_mov_b32 s98, 3
L_flg:
    ds_read_b96 v[48:50], v9
    s_waitcnt lgkmcnt(0)
    v_add3_u32 v48, v48, v49, v50
    v_cmp_eq_u32 vcc, 3, v48
    s_cmp_eq_u64 vcc, -1
    s_cbranch_scc1 L_flg_ok
    s_sub_u32 s70, s70, 1
    s_cmp_gt_i32 s70, 0
    s_cbranch_scc1 L_flg
L_flg_ok:
    ds_read_b128 v[64:67], v13 offset:28672
    ds_read_b128 v[68:71], v13 offset:30720
    ds_read_b128 v[72:75], v13 offset:32768
    ds_read_b128 v[76:79], v13 offset:34816
    s_waitcnt lgkmcnt(2)
    v_add_f32 v64, v64, v68
    v_add_f32 v65, v65, v69
    v_add_f32 v66, v66, v70
    v_add_f32 v67, v67, v71
    s_waitcnt lgkmcnt(0)
    v_add_f32 v72, v72, v76
    v_add_f32 v73, v73, v77
    v_add_f32 v74, v74, v78
    v_add_f32 v75, v75, v79
    v_add_f32 v64, v64, v72
    v_add_f32 v65, v65, v73
    v_add_f32 v66, v66, v74
    v_add_f32 v67, v67, v75
    v_cvt_pk_bf16_f32 v8, v64, v65
    v_cvt_pk_bf16_f32 v9, v66, v67
    buffer_store_dwordx4 v[8:11], v6, s[28:31], s100 offen
    s_branch L_kloads
L_stream0:
    s_lshl_b32 s58, s57, 3
    s_add_u32 s58, s58, s55
    s_and_b32 s75, s56, 7
    s_lshr_b32 s71, s56, 3
    s_lshl_b32 s3, s75, 24
    s_lshl_b32 s6, s55, 21
    s_add_u32 s6, s6, s3
    s_lshl_b32 s3, s71, 18
    s_add_u32 s6, s6, s3
    s_add_u32 s6, s6, 0x180000
    s_mul_i32 s60, s54, 2
    s_mul_i32 s3, s75, 3
    s_add_u32 s60, s60, s3
    s_mul_i32 s3, s55, 1
    s_add_u32 s60, s60, s3
    s_mul_i32 s3, s71, 4
    s_add_u32 s60, s60, s3
    s_mul_i32 s3, s57, 2
    s_add_u32 s60, s60, s3
    s_lshl_b32 s60, s60, 12
    s_and_b32 s60, s60, 0x7fff
    s_add_u32 s61, s60, 4096
    s_and_b32 s61, s61, 0x7fff
    s_add_u32 s62, s61, 4096
    s_and_b32 s62, s62, 0x7fff
    s_add_u32 s63, s62, 4096
    s_and_b32 s63, s63, 0x7fff
    s_add_u32 s64, s63, 4096
    s_and_b32 s64, s64, 0x7fff
    s_add_u32 s65, s64, 4096
    s_and_b32 s65, s65, 0x7fff
    s_add_u32 s66, s65, 4096
    s_and_b32 s66, s66, 0x7fff
    s_add_u32 s67, s66, 4096
    s_and_b32 s67, s67, 0x7fff
    s_mov_b32 s70, 200000
    s_lshl_b32 s3, s54, 15
    v_lshrrev_b32 v5, 2, v2
    v_lshlrev_b32 v4, 9, v5
    v_lshl_add_u32 v4, v15, 4, v4
    v_lshl_add_u32 v4, v3, 6, v4
    v_add_u32 v4, s3, v4
    v_lshl_add_u32 v5, v3, 9, v60
    v_add_u32 v5, s3, v5
    v_lshlrev_b32 v12, 4, v1
    s_mov_b32 s30, 8388608
    s_mov_b32 s31, 0x20000
    s_mov_b32 s22, 0x40000
    s_mov_b32 s23, 0x20000
    s_mov_b32 s26, 0x40000
    s_mov_b32 s27, 0x20000
    s_waitcnt lgkmcnt(0)
    s_add_u32 s94, s28, 2031616
    s_addc_u32 s95, s29, 0
    s_add_u32 s20, s8, s6
    s_addc_u32 s21, s9, 0
    s_add_u32 s24, s10, s6
    s_addc_u32 s25, s11, 0
    s_load_dwordx2 s[52:53], s[94:95], 0
    s_barrier
L_kloads:
    s_bitcmp1_b32 s2, 0
    s_cselect_b64 vcc, -1, 0
    s_lshr_b32 s3, s56, 1
    s_cmp_eq_u32 s3, 3
    buffer_load_dwordx4 v[128:131], v4, s[20:23], s60 offen offset:0 nt
    buffer_load_dwordx4 v[132:135], v4, s[20:23], s60 offen offset:256 nt
    s_nop 0
    buffer_load_dwordx4 v[136:139], v4, s[20:23], s60 offen offset:2048 nt
    buffer_load_dwordx4 v[140:143], v4, s[20:23], s60 offen offset:2304 nt
    s_nop 0
    buffer_load_dwordx4 v[144:147], v4, s[20:23], s61 offen offset:0 nt
    buffer_load_dwordx4 v[148:151], v4, s[20:23], s61 offen offset:256 nt
    s_nop 0
    buffer_load_dwordx4 v[152:155], v4, s[20:23], s61 offen offset:2048 nt
    buffer_load_dwordx4 v[156:159], v4, s[20:23], s61 offen offset:2304 nt
    s_nop 0
    buffer_load_dwordx4 v[160:163], v4, s[20:23], s62 offen offset:0 nt
    buffer_load_dwordx4 v[164:167], v4, s[20:23], s62 offen offset:256 nt
    s_nop 0
    buffer_load_dwordx4 v[168:171], v4, s[20:23], s62 offen offset:2048 nt
    buffer_load_dwordx4 v[172:175], v4, s[20:23], s62 offen offset:2304 nt
    s_nop 0
    s_cmp_eq_u32 s54, 7
    s_cbranch_scc1 L_nosetup
    v_and_b32 v6, 1, v2
    v_cmp_eq_u32 vcc, 1, v6
    v_mov_b32 v7, 0x0c0c0100
    v_mov_b32 v8, 0x01000c0c
    v_mov_b32 v9, 0x0c0c0302
    v_mov_b32 v10, 0x03020c0c
    v_cndmask_b32 v7, v7, v8, vcc
    v_cndmask_b32 v9, v9, v10, vcc
    v_bfe_u32 v6, v2, 1, 2
    v_mov_b32 v8, 0x0c0c0c0c
    v_cmp_eq_u32 vcc, 0, v6
    s_nop 1
    v_cndmask_b32 v32, v8, v7, vcc
    v_cndmask_b32 v33, v8, v9, vcc
    v_cmp_eq_u32 vcc, 1, v6
    s_nop 1
    v_cndmask_b32 v34, v8, v7, vcc
    v_cndmask_b32 v35, v8, v9, vcc
    v_cmp_eq_u32 vcc, 2, v6
    s_nop 1
    v_cndmask_b32 v36, v8, v7, vcc
    v_cndmask_b32 v37, v8, v9, vcc
    v_cmp_eq_u32 vcc, 3, v6
    s_nop 1
    v_cndmask_b32 v38, v8, v7, vcc
    v_cndmask_b32 v39, v8, v9, vcc
    v_and_b32 v9, 1, v3
    v_lshrrev_b32 v10, 1, v3
    v_lshlrev_b32 v48, 10, v10
    v_lshl_add_u32 v48, v2, 5, v48
    v_lshl_add_u32 v48, v9, 4, v48
    s_lshl_b32 s3, s54, 11
    v_add_u32 v48, s3, v48
    v_lshlrev_b32 v49, 6, v2
    v_lshl_add_u32 v49, v3, 4, v49
    s_lshl_b32 s72, s58, 15
    s_add_u32 s72, s72, 524288
    s_lshl_b32 s90, s71, 14
    s_add_u32 s90, s90, s72
    s_add_u32 s90, s90, s3
    s_lshl_b32 s91, s58, 9
    s_add_u32 s91, s91, 1048576
    s_lshr_b32 s3, s54, 1
    s_lshl_b32 s3, s3, 8
    s_add_u32 s74, s91, s3
    s_lshl_b32 s3, s56, 4
    s_add_u32 s74, s74, s3
    s_lshl_b32 s3, s71, 8
    s_add_u32 s91, s91, s3
    s_lshl_b32 s73, s58, 1
    s_add_u32 s73, s73, s71
    s_lshl_b32 s73, s73, 8
    s_lshl_b32 s59, s75, 17
    s_add_u32 s73, s73, s59
    s_add_u32 s73, s73, 1114112
    v_lshrrev_b32 v52, 2, v2
    v_lshl_add_u32 v52, v3, 2, v52
    v_lshlrev_b32 v52, 7, v52
    v_lshl_add_u32 v52, v15, 3, v52
    s_lshl_b32 s3, s54, 5
    s_add_u32 s3, s3, 65536
    v_add_u32 v52, s3, v52
    s_lshl_b32 s3, s54, 10
    v_add_u32 v53, s3, v12
    v_and_b32 v8, 7, v2
    v_lshlrev_b32 v58, 14, v8
    v_lshl_add_u32 v58, v3, 5, v58
    v_lshrrev_b32 v8, 3, v2
    v_lshl_add_u32 v58, v8, 4, v58
    s_lshr_b32 s59, s54, 1
    s_lshl_b32 s59, s59, 13
    s_add_u32 s73, s73, s59
    s_and_b32 s59, s54, 1
    s_lshl_b32 s59, s59, 7
    s_add_u32 s73, s73, s59
    v_lshrrev_b32 v6, 5, v1
    v_and_b32 v7, 31, v1
    v_lshlrev_b32 v54, 13, v6
    v_lshl_add_u32 v54, v7, 4, v54
    s_lshl_b32 s3, s54, 9
    v_add_u32 v54, s3, v54
    s_lshr_b32 s3, s54, 1
    s_lshl_b32 s3, s3, 6
    v_lshlrev_b32 v57, 4, v6
    v_add_u32 v57, s3, v57
    v_lshrrev_b32 v6, 3, v1
    v_and_b32 v7, 7, v1
    v_lshrrev_b32 v56, 2, v1
    v_lshlrev_b32 v56, 10, v56
    v_lshl_add_u32 v56, v15, 4, v56
    v_mul_u32_u24 v55, 896, v6
    v_lshl_add_u32 v55, v7, 4, v55
    s_lshl_b32 s3, s54, 13
    s_add_u32 s72, s72, s3
    s_lshl_b32 s3, s56, 6
    s_add_u32 s72, s72, s3
    v_lshrrev_b32 v6, 3, v2
    v_lshlrev_b32 v59, 6, v6
    s_lshl_b32 s3, s54, 2
    v_add_u32 v59, s3, v59
    s_cmp_lt_u32 s2, 128
    s_cselect_b32 s89, 1, 0
    s_cmp_lt_u32 s55, 7
    s_cselect_b32 s89, s89, 0
    s_lshl_b32 s3, s55, 1
    s_add_u32 s3, s3, s71
    s_mul_i32 s3, s3, 229376
    s_lshl_b32 s59, s75, 7
    s_add_u32 s3, s3, s59
    s_add_u32 s32, s14, s3
    s_addc_u32 s33, s15, 0
    s_sub_u32 s34, 3670016, s3
    s_mov_b32 s35, 0x20000
    s_mul_i32 s80, s54, 57344
    s_lshl_b32 s59, s54, 13
    s_add_u32 m0, s59, 65536
    s_add_u32 s81, s80, 6144
    s_add_u32 s82, s80, 12288
    s_add_u32 s83, s80, 18432
    s_add_u32 s84, s80, 28672
    s_add_u32 s85, s80, 34816
    s_add_u32 s86, s80, 40960
    s_add_u32 s87, s80, 47104
    v_lshlrev_b32 v6, 9, v6
    v_lshl_add_u32 v6, v15, 4, v6
    v_lshl_add_u32 v30, v3, 6, v6
L_nosetup:
    s_bitcmp1_b32 s2, 0
    s_cselect_b64 vcc, -1, 0
    s_lshr_b32 s3, s56, 1
    s_cmp_eq_u32 s3, 3
    buffer_load_dwordx4 v[176:179], v4, s[20:23], s63 offen offset:0 nt
    buffer_load_dwordx4 v[180:183], v4, s[20:23], s63 offen offset:256 nt
    s_cbranch_scc1 L_z6
    s_waitcnt vmcnt(7)
    s_cbranch_vccnz L_z6
    s_waitcnt vmcnt(5)
L_z6:
    buffer_load_dwordx4 v[184:187], v4, s[20:23], s63 offen offset:2048 nt
    buffer_load_dwordx4 v[188:191], v4, s[20:23], s63 offen offset:2304 nt
    s_cbranch_scc1 L_z7
    s_waitcnt vmcnt(7)
    s_cbranch_vccnz L_z7
    s_waitcnt vmcnt(5)
L_z7:
    s_cmp_lg_u32 s54, 7
    s_cbranch_scc1 L_nopoll1
    buffer_load_dwordx4 v[48:51], v12, s[28:31], s74 offen sc1
    buffer_load_dwordx4 v[52:55], v12, s[28:31], s74 offen offset:1024 sc1
L_nopoll1:
    s_bitcmp1_b32 s2, 0
    s_cselect_b64 vcc, -1, 0
    s_lshr_b32 s3, s56, 1
    s_cmp_eq_u32 s3, 3
    buffer_load_dwordx4 v[192:195], v4, s[20:23], s64 offen offset:0 nt
    buffer_load_dwordx4 v[196:199], v4, s[20:23], s64 offen offset:256 nt
    s_cbranch_scc1 L_z8
    s_waitcnt vmcnt(7)
    s_cbranch_vccnz L_z8
    s_waitcnt vmcnt(5)
L_z8:
    buffer_load_dwordx4 v[200:203], v4, s[20:23], s64 offen offset:2048 nt
    buffer_load_dwordx4 v[204:207], v4, s[20:23], s64 offen offset:2304 nt
    s_cbranch_scc1 L_z9
    s_waitcnt vmcnt(7)
    s_cbranch_vccnz L_z9
    s_waitcnt vmcnt(5)
L_z9:
    buffer_load_dwordx4 v[208:211], v4, s[20:23], s65 offen offset:0 nt
    buffer_load_dwordx4 v[212:215], v4, s[20:23], s65 offen offset:256 nt
    s_cbranch_scc1 L_z10
    s_waitcnt vmcnt(7)
    s_cbranch_vccnz L_z10
    s_waitcnt vmcnt(5)
L_z10:
    buffer_load_dwordx4 v[216:219], v4, s[20:23], s65 offen offset:2048 nt
    buffer_load_dwordx4 v[220:223], v4, s[20:23], s65 offen offset:2304 nt
    s_cbranch_scc1 L_z11
    s_waitcnt vmcnt(7)
    s_cbranch_vccnz L_z11
    s_waitcnt vmcnt(5)
L_z11:
    s_cmp_lg_u32 s54, 7
    s_cbranch_scc1 L_nochk
    s_waitcnt vmcnt(8)
    s_branch L_qchk
L_qpoll:
    buffer_load_dwordx4 v[48:51], v12, s[28:31], s74 offen sc1
    buffer_load_dwordx4 v[52:55], v12, s[28:31], s74 offen offset:1024 sc1
    s_waitcnt vmcnt(0)
L_qchk:
    v_and_b32 v56, -16, v50
    v_and_b32 v58, -16, v54
    v_mov_b32 v57, v51
    v_mov_b32 v59, v55
    s_mov_b32 s90, s97
    s_mov_b32 s91, s53
    v_cmp_eq_u64 vcc, s[90:91], v[56:57]
    v_cmp_eq_u64 s[68:69], s[90:91], v[58:59]
    v_cmp_eq_u32 s[92:93], s96, v50
    v_cmp_eq_u32 s[94:95], s96, v54
    s_and_b64 vcc, vcc, s[68:69]
    s_and_b64 s[92:93], s[92:93], s[94:95]
    s_sub_u32 s98, s98, 1
    s_cmp_eq_u64 vcc, -1
    s_cselect_b32 s3, -1, s98
    s_cmp_eq_u64 s[92:93], -1
    s_cselect_b32 s3, 0, s3
    s_cmp_lt_i32 s3, 0
    s_cbranch_scc0 L_qnorep
    buffer_store_dwordx4 v[8:11], v6, s[28:31], s100 offen sc1
L_qnorep:
    s_cmp_eq_u64 vcc, -1
    s_cbranch_scc1 L_qpoll_ok
    s_sleep 4
    s_sub_u32 s70, s70, 1
    s_cmp_gt_i32 s70, 0
    s_cbranch_scc1 L_qpoll
L_qpoll_ok:
    v_lshlrev_b32 v6, 3, v1
    ds_write_b64 v6, v[48:49] offset:63488
    ds_write_b64 v6, v[52:53] offset:64000
    v_mov_b32 v6, 64652
    s_and_b64 s[92:93], s[92:93], vcc
    s_cmp_eq_u64 s[92:93], -1
    s_cselect_b32 s3, 1, 0
    v_mov_b32 v7, s3
    ds_write_b32 v6, v7
    s_setprio 0
L_nochk:
    s_bitcmp1_b32 s2, 0
    s_cselect_b64 vcc, -1, 0
    s_lshr_b32 s3, s56, 1
    s_cmp_eq_u32 s3, 3
    buffer_load_dwordx4 v[224:227], v4, s[20:23], s66 offen offset:0 nt
    buffer_load_dwordx4 v[228:231], v4, s[20:23], s66 offen offset:256 nt
    s_cbranch_scc1 L_z12
    s_waitcnt vmcnt(7)
    s_cbranch_vccnz L_z12
    s_waitcnt vmcnt(5)
L_z12:
    buffer_load_dwordx4 v[232:235], v4, s[20:23], s66 offen offset:2048 nt
    buffer_load_dwordx4 v[236:239], v4, s[20:23], s66 offen offset:2304 nt
    s_cbranch_scc1 L_z13
    s_waitcnt vmcnt(7)
    s_cbranch_vccnz L_z13
    s_waitcnt vmcnt(5)
L_z13:
    buffer_load_dwordx4 v[240:243], v4, s[20:23], s67 offen offset:0 nt
    buffer_load_dwordx4 v[244:247], v4, s[20:23], s67 offen offset:256 nt
    s_cbranch_scc1 L_z14
    s_waitcnt vmcnt(7)
    s_cbranch_vccnz L_z14
    s_waitcnt vmcnt(5)
L_z14:
    buffer_load_dwordx4 v[248:251], v4, s[20:23], s67 offen offset:2048 nt
    buffer_load_dwordx4 v[252:255], v4, s[20:23], s67 offen offset:2304 nt
    s_cbranch_scc1 L_z15
    s_waitcnt vmcnt(7)
    s_cbranch_vccnz L_z15
    s_waitcnt vmcnt(5)
L_z15:
    buffer_load_dwordx4 v[64:67], v5, s[24:27], s60 offen offset:0 nt
    buffer_load_dwordx4 v[68:71], v5, s[24:27], s60 offen offset:256 nt
    s_cbranch_scc1 L_z16
    s_waitcnt vmcnt(7)
    s_cbranch_vccnz L_z16
    s_waitcnt vmcnt(5)
L_z16:
    buffer_load_dwordx4 v[72:75], v5, s[24:27], s60 offen offset:2048 nt
    buffer_load_dwordx4 v[76:79], v5, s[24:27], s60 offen offset:2304 nt
    s_cbranch_scc1 L_z17
    s_waitcnt vmcnt(7)
    s_cbranch_vccnz L_z17
    s_waitcnt vmcnt(5)
L_z17:
    buffer_load_dwordx4 v[80:83], v5, s[24:27], s61 offen offset:0 nt
    buffer_load_dwordx4 v[84:87], v5, s[24:27], s61 offen offset:256 nt
    s_cbranch_scc1 L_z18
    s_waitcnt vmcnt(7)
    s_cbranch_vccnz L_z18
    s_waitcnt vmcnt(5)
L_z18:
    buffer_load_dwordx4 v[88:91], v5, s[24:27], s61 offen offset:2048 nt
    buffer_load_dwordx4 v[92:95], v5, s[24:27], s61 offen offset:2304 nt
    s_cbranch_scc1 L_z19
    s_waitcnt vmcnt(7)
    s_cbranch_vccnz L_z19
    s_waitcnt vmcnt(5)
L_z19:
    buffer_load_dwordx4 v[96:99], v5, s[24:27], s62 offen offset:0 nt
    buffer_load_dwordx4 v[100:103], v5, s[24:27], s62 offen offset:256 nt
    s_cbranch_scc1 L_z20
    s_waitcnt vmcnt(7)
    s_cbranch_vccnz L_z20
    s_waitcnt vmcnt(5)
L_z20:
    buffer_load_dwordx4 v[104:107], v5, s[24:27], s62 offen offset:2048 nt
    buffer_load_dwordx4 v[108:111], v5, s[24:27], s62 offen offset:2304 nt
    s_cbranch_scc1 L_z21
    s_waitcnt vmcnt(7)
    s_cbranch_vccnz L_z21
    s_waitcnt vmcnt(5)
L_z21:
    buffer_load_dwordx4 v[112:115], v5, s[24:27], s63 offen offset:0 nt
    buffer_load_dwordx4 v[116:119], v5, s[24:27], s63 offen offset:256 nt
    s_cbranch_scc1 L_z22
    s_waitcnt vmcnt(7)
    s_cbranch_vccnz L_z22
    s_waitcnt vmcnt(5)
L_z22:
    buffer_load_dwordx4 v[120:123], v5, s[24:27], s63 offen offset:2048 nt
    buffer_load_dwordx4 v[124:127], v5, s[24:27], s63 offen offset:2304 nt
    s_cbranch_scc1 L_z23
    s_waitcnt vmcnt(7)
    s_cbranch_vccnz L_z23
    s_waitcnt vmcnt(5)
L_z23:
L_noq:
    s_cmp_ge_u32 s54, 4
    s_waitcnt lgkmcnt(0)
    s_cbranch_scc1 L_tagdone
    s_add_u32 s52, s52, 0x7f4a7c15
    s_addc_u32 s53, s53, 0x9e3779b9
L_tagdone:
    s_cmp_lg_u32 s54, 7
    s_cbranch_scc1 L_setupdone
    v_and_b32 v6, 1, v2
    v_cmp_eq_u32 vcc, 1, v6
    v_mov_b32 v7, 0x0c0c0100
    v_mov_b32 v8, 0x01000c0c
    v_mov_b32 v9, 0x0c0c0302
    v_mov_b32 v10, 0x03020c0c
    v_cndmask_b32 v7, v7, v8, vcc
    v_cndmask_b32 v9, v9, v10, vcc
    v_bfe_u32 v6, v2, 1, 2
    v_mov_b32 v8, 0x0c0c0c0c
    v_cmp_eq_u32 vcc, 0, v6
    s_nop 1
    v_cndmask_b32 v32, v8, v7, vcc
    v_cndmask_b32 v33, v8, v9, vcc
    v_cmp_eq_u32 vcc, 1, v6
    s_nop 1
    v_cndmask_b32 v34, v8, v7, vcc
    v_cndmask_b32 v35, v8, v9, vcc
    v_cmp_eq_u32 vcc, 2, v6
    s_nop 1
    v_cndmask_b32 v36, v8, v7, vcc
    v_cndmask_b32 v37, v8, v9, vcc
    v_cmp_eq_u32 vcc, 3, v6
    s_nop 1
    v_cndmask_b32 v38, v8, v7, vcc
    v_cndmask_b32 v39, v8, v9, vcc
    v_and_b32 v9, 1, v3
    v_lshrrev_b32 v10, 1, v3
    v_lshlrev_b32 v48, 10, v10
    v_lshl_add_u32 v48, v2, 5, v48
    v_lshl_add_u32 v48, v9, 4, v48
    s_lshl_b32 s3, s54, 11
    v_add_u32 v48, s3, v48
    v_lshlrev_b32 v49, 6, v2
    v_lshl_add_u32 v49, v3, 4, v49
    s_lshl_b32 s72, s58, 15
    s_add_u32 s72, s72, 524288
    s_lshl_b32 s90, s71, 14
    s_add_u32 s90, s90, s72
    s_add_u32 s90, s90, s3
    s_lshl_b32 s91, s58, 9
    s_add_u32 s91, s91, 1048576
    s_lshr_b32 s3, s54, 1
    s_lshl_b32 s3, s3, 8
    s_add_u32 s74, s91, s3
    s_lshl_b32 s3, s56, 4
    s_add_u32 s74, s74, s3
    s_lshl_b32 s3, s71, 8
    s_add_u32 s91, s91, s3
    s_lshl_b32 s73, s58, 1
    s_add_u32 s73, s73, s71
    s_lshl_b32 s73, s73, 8
    s_lshl_b32 s59, s75, 17
    s_add_u32 s73, s73, s59
    s_add_u32 s73, s73, 1114112
    v_lshrrev_b32 v52, 2, v2
    v_lshl_add_u32 v52, v3, 2, v52
    v_lshlrev_b32 v52, 7, v52
    v_lshl_add_u32 v52, v15, 3, v52
    s_lshl_b32 s3, s54, 5
    s_add_u32 s3, s3, 65536
    v_add_u32 v52, s3, v52
    s_lshl_b32 s3, s54, 10
    v_add_u32 v53, s3, v12
    v_and_b32 v8, 7, v2
    v_lshlrev_b32 v58, 14, v8
    v_lshl_add_u32 v58, v3, 5, v58
    v_lshrrev_b32 v8, 3, v2
    v_lshl_add_u32 v58, v8, 4, v58
    s_lshr_b32 s59, s54, 1
    s_lshl_b32 s59, s59, 13
    s_add_u32 s73, s73, s59
    s_and_b32 s59, s54, 1
    s_lshl_b32 s59, s59, 7
    s_add_u32 s73, s73, s59
    v_lshrrev_b32 v6, 5, v1
    v_and_b32 v7, 31, v1
    v_lshlrev_b32 v54, 13, v6
    v_lshl_add_u32 v54, v7, 4, v54
    s_lshl_b32 s3, s54, 9
    v_add_u32 v54, s3, v54
    s_lshr_b32 s3, s54, 1
    s_lshl_b32 s3, s3, 6
    v_lshlrev_b32 v57, 4, v6
    v_add_u32 v57, s3, v57
    v_lshrrev_b32 v6, 3, v1
    v_and_b32 v7, 7, v1
    v_lshrrev_b32 v56, 2, v1
    v_lshlrev_b32 v56, 10, v56
    v_lshl_add_u32 v56, v15, 4, v56
    v_mul_u32_u24 v55, 896, v6
    v_lshl_add_u32 v55, v7, 4, v55
    s_lshl_b32 s3, s54, 13
    s_add_u32 s72, s72, s3
    s_lshl_b32 s3, s56, 6
    s_add_u32 s72, s72, s3
    v_lshrrev_b32 v6, 3, v2
    v_lshlrev_b32 v59, 6, v6
    s_lshl_b32 s3, s54, 2
    v_add_u32 v59, s3, v59
    s_cmp_lt_u32 s2, 128
    s_cselect_b32 s89, 1, 0
    s_cmp_lt_u32 s55, 7
    s_cselect_b32 s89, s89, 0
    s_lshl_b32 s3, s55, 1
    s_add_u32 s3, s3, s71
    s_mul_i32 s3, s3, 229376
    s_lshl_b32 s59, s75, 7
    s_add_u32 s3, s3, s59
    s_add_u32 s32, s14, s3
    s_addc_u32 s33, s15, 0
    s_sub_u32 s34, 3670016, s3
    s_mov_b32 s35, 0x20000
    s_mul_i32 s80, s54, 57344
    s_lshl_b32 s59, s54, 13
    s_add_u32 m0, s59, 65536
    s_add_u32 s81, s80, 6144
    s_add_u32 s82, s80, 12288
    s_add_u32 s83, s80, 18432
    s_add_u32 s84, s80, 28672
    s_add_u32 s85, s80, 34816
    s_add_u32 s86, s80, 40960
    s_add_u32 s87, s80, 47104
    v_lshlrev_b32 v6, 9, v6
    v_lshl_add_u32 v6, v15, 4, v6
    v_lshl_add_u32 v30, v3, 6, v6
L_setupdone:
    v_mov_b32 v7, -1
    s_mov_b64 exec, 0x101
    ds_write_b32 v59, v7 offset:64512
    s_mov_b64 exec, -1
    s_waitcnt lgkmcnt(0)
    s_barrier
    ds_read_b128 v[16:19], v30 offset:63488
    ds_read_b128 v[20:23], v30 offset:63744
    v_mov_b32 v7, 64652
    ds_read_b32 v7, v7
    s_waitcnt lgkmcnt(0)
    v_readfirstlane_b32 s99, v7
    s_cmp_ge_u32 s54, 4
    s_cbranch_scc1 L_qk47
    s_setprio 2
    s_waitcnt vmcnt(46)
    v_mfma_f32_16x16x32_bf16 v[128:131], v[128:131], v[16:19], 0
    v_mfma_f32_16x16x32_bf16 v[128:131], v[132:135], v[20:23], v[128:131]
    s_waitcnt vmcnt(44)
    v_mfma_f32_16x16x32_bf16 v[136:139], v[136:139], v[16:19], 0
    v_mfma_f32_16x16x32_bf16 v[136:139], v[140:143], v[20:23], v[136:139]
    buffer_load_dwordx4 v[132:135], v5, s[24:27], s64 offen offset:0 nt
    buffer_load_dwordx4 v[140:143], v5, s[24:27], s64 offen offset:256 nt
    s_nop 0
    s_waitcnt vmcnt(44)
    v_mfma_f32_16x16x32_bf16 v[144:147], v[144:147], v[16:19], 0
    v_mfma_f32_16x16x32_bf16 v[144:147], v[148:151], v[20:23], v[144:147]
    s_waitcnt vmcnt(42)
    v_mfma_f32_16x16x32_bf16 v[152:155], v[152:155], v[16:19], 0
    v_mfma_f32_16x16x32_bf16 v[152:155], v[156:159], v[20:23], v[152:155]
    buffer_load_dwordx4 v[148:151], v5, s[24:27], s64 offen offset:2048 nt
    buffer_load_dwordx4 v[156:159], v5, s[24:27], s64 offen offset:2304 nt
    s_nop 0
    s_waitcnt vmcnt(42)
    v_mfma_f32_16x16x32_bf16 v[160:163], v[160:163], v[16:19], 0
    v_mfma_f32_16x16x32_bf16 v[160:163], v[164:167], v[20:23], v[160:163]
    s_waitcnt vmcnt(40)
    v_mfma_f32_16x16x32_bf16 v[168:171], v[168:171], v[16:19], 0
    v_mfma_f32_16x16x32_bf16 v[168:171], v[172:175], v[20:23], v[168:171]
    buffer_load_dwordx4 v[164:167], v5, s[24:27], s65 offen offset:0 nt
    buffer_load_dwordx4 v[172:175], v5, s[24:27], s65 offen offset:256 nt
    s_nop 0
    s_waitcnt vmcnt(40)
    v_mfma_f32_16x16x32_bf16 v[176:179], v[176:179], v[16:19], 0
    v_mfma_f32_16x16x32_bf16 v[176:179], v[180:183], v[20:23], v[176:179]
    s_waitcnt vmcnt(38)
    v_mfma_f32_16x16x32_bf16 v[184:187], v[184:187], v[16:19], 0
    v_mfma_f32_16x16x32_bf16 v[184:187], v[188:191], v[20:23], v[184:187]
    buffer_load_dwordx4 v[180:183], v5, s[24:27], s65 offen offset:2048 nt
    buffer_load_dwordx4 v[188:191], v5, s[24:27], s65 offen offset:2304 nt
    s_nop 0
    s_waitcnt vmcnt(38)
    v_mfma_f32_16x16x32_bf16 v[192:195], v[192:195], v[16:19], 0
    v_mfma_f32_16x16x32_bf16 v[192:195], v[196:199], v[20:23], v[192:195]
    s_waitcnt vmcnt(36)
    v_mfma_f32_16x16x32_bf16 v[200:203], v[200:203], v[16:19], 0
    v_mfma_f32_16x16x32_bf16 v[200:203], v[204:207], v[20:23], v[200:203]
    buffer_load_dwordx4 v[196:199], v5, s[24:27], s66 offen offset:0 nt
    buffer_load_dwordx4 v[204:207], v5, s[24:27], s66 offen offset:256 nt
    s_nop 0
    s_waitcnt vmcnt(36)
    v_mfma_f32_16x16x32_bf16 v[208:211], v[208:211], v[16:19], 0
    v_mfma_f32_16x16x32_bf16 v[208:211], v[212:215], v[20:23], v[208:211]
    s_waitcnt vmcnt(34)
    v_mfma_f32_16x16x32_bf16 v[216:219], v[216:219], v[16:19], 0
    v_mfma_f32_16x16x32_bf16 v[216:219], v[220:223], v[20:23], v[216:219]
    buffer_load_dwordx4 v[212:215], v5, s[24:27], s66 offen offset:2048 nt
    buffer_load_dwordx4 v[220:223], v5, s[24:27], s66 offen offset:2304 nt
    s_nop 0
    s_waitcnt vmcnt(34)
    v_mfma_f32_16x16x32_bf16 v[224:227], v[224:227], v[16:19], 0
    v_mfma_f32_16x16x32_bf16 v[224:227], v[228:231], v[20:23], v[224:227]
    s_waitcnt vmcnt(32)
    v_mfma_f32_16x16x32_bf16 v[232:235], v[232:235], v[16:19], 0
    v_mfma_f32_16x16x32_bf16 v[232:235], v[236:239], v[20:23], v[232:235]
    buffer_load_dwordx4 v[228:231], v5, s[24:27], s67 offen offset:0 nt
    buffer_load_dwordx4 v[236:239], v5, s[24:27], s67 offen offset:256 nt
    s_nop 0
    s_waitcnt vmcnt(32)
    v_mfma_f32_16x16x32_bf16 v[240:243], v[240:243], v[16:19], 0
    v_mfma_f32_16x16x32_bf16 v[240:243], v[244:247], v[20:23], v[240:243]
    s_waitcnt vmcnt(30)
    v_mfma_f32_16x16x32_bf16 v[248:251], v[248:251], v[16:19], 0
    v_mfma_f32_16x16x32_bf16 v[248:251], v[252:255], v[20:23], v[248:251]
    buffer_load_dwordx4 v[244:247], v5, s[24:27], s67 offen offset:2048 nt
    buffer_load_dwordx4 v[252:255], v5, s[24:27], s67 offen offset:2304 nt
    s_nop 0
    s_setprio 0
    s_branch L_nov1
L_qk47:
    s_waitcnt vmcnt(46)
    v_mfma_f32_16x16x32_bf16 v[128:131], v[128:131], v[16:19], 0
    v_mfma_f32_16x16x32_bf16 v[128:131], v[132:135], v[20:23], v[128:131]
    s_waitcnt vmcnt(44)
    v_mfma_f32_16x16x32_bf16 v[136:139], v[136:139], v[16:19], 0
    v_mfma_f32_16x16x32_bf16 v[136:139], v[140:143], v[20:23], v[136:139]
    s_waitcnt vmcnt(42)
    v_mfma_f32_16x16x32_bf16 v[144:147], v[144:147], v[16:19], 0
    v_mfma_f32_16x16x32_bf16 v[144:147], v[148:151], v[20:23], v[144:147]
    s_waitcnt vmcnt(40)
    v_mfma_f32_16x16x32_bf16 v[152:155], v[152:155], v[16:19], 0
    v_mfma_f32_16x16x32_bf16 v[152:155], v[156:159], v[20:23], v[152:155]
    s_waitcnt vmcnt(38)
    v_mfma_f32_16x16x32_bf16 v[160:163], v[160:163], v[16:19], 0
    v_mfma_f32_16x16x32_bf16 v[160:163], v[164:167], v[20:23], v[160:163]
    s_waitcnt vmcnt(36)
    v_mfma_f32_16x16x32_bf16 v[168:171], v[168:171], v[16:19], 0
    v_mfma_f32_16x16x32_bf16 v[168:171], v[172:175], v[20:23], v[168:171]
    s_waitcnt vmcnt(34)
    v_mfma_f32_16x16x32_bf16 v[176:179], v[176:179], v[16:19], 0
    v_mfma_f32_16x16x32_bf16 v[176:179], v[180:183], v[20:23], v[176:179]
    s_waitcnt vmcnt(32)
    v_mfma_f32_16x16x32_bf16 v[184:187], v[184:187], v[16:19], 0
    v_mfma_f32_16x16x32_bf16 v[184:187], v[188:191], v[20:23], v[184:187]
    s_waitcnt vmcnt(30)
    v_mfma_f32_16x16x32_bf16 v[192:195], v[192:195], v[16:19], 0
    v_mfma_f32_16x16x32_bf16 v[192:195], v[196:199], v[20:23], v[192:195]
    s_waitcnt vmcnt(28)
    v_mfma_f32_16x16x32_bf16 v[200:203], v[200:203], v[16:19], 0
    v_mfma_f32_16x16x32_bf16 v[200:203], v[204:207], v[20:23], v[200:203]
    s_waitcnt vmcnt(26)
    v_mfma_f32_16x16x32_bf16 v[208:211], v[208:211], v[16:19], 0
    v_mfma_f32_16x16x32_bf16 v[208:211], v[212:215], v[20:23], v[208:211]
    s_waitcnt vmcnt(24)
    v_mfma_f32_16x16x32_bf16 v[216:219], v[216:219], v[16:19], 0
    v_mfma_f32_16x16x32_bf16 v[216:219], v[220:223], v[20:23], v[216:219]
    s_waitcnt vmcnt(22)
    v_mfma_f32_16x16x32_bf16 v[224:227], v[224:227], v[16:19], 0
    v_mfma_f32_16x16x32_bf16 v[224:227], v[228:231], v[20:23], v[224:227]
    s_waitcnt vmcnt(20)
    v_mfma_f32_16x16x32_bf16 v[232:235], v[232:235], v[16:19], 0
    v_mfma_f32_16x16x32_bf16 v[232:235], v[236:239], v[20:23], v[232:235]
    s_waitcnt vmcnt(18)
    v_mfma_f32_16x16x32_bf16 v[240:243], v[240:243], v[16:19], 0
    v_mfma_f32_16x16x32_bf16 v[240:243], v[244:247], v[20:23], v[240:243]
    s_waitcnt vmcnt(16)
    v_mfma_f32_16x16x32_bf16 v[248:251], v[248:251], v[16:19], 0
    v_mfma_f32_16x16x32_bf16 v[248:251], v[252:255], v[20:23], v[248:251]
L_nov1:
    v_mov_b32_dpp v128, v128 quad_perm:[0,0,0,0] row_mask:0xf bank_mask:0xf
    v_mov_b32_dpp v136, v136 quad_perm:[0,0,0,0] row_mask:0xf bank_mask:0xf
    v_mov_b32_dpp v144, v144 quad_perm:[0,0,0,0] row_mask:0xf bank_mask:0xf
    v_mov_b32_dpp v152, v152 quad_perm:[0,0,0,0] row_mask:0xf bank_mask:0xf
    v_mov_b32_dpp v160, v160 quad_perm:[0,0,0,0] row_mask:0xf bank_mask:0xf
    v_mov_b32_dpp v168, v168 quad_perm:[0,0,0,0] row_mask:0xf bank_mask:0xf
    v_mov_b32_dpp v176, v176 quad_perm:[0,0,0,0] row_mask:0xf bank_mask:0xf
    v_mov_b32_dpp v184, v184 quad_perm:[0,0,0,0] row_mask:0xf bank_mask:0xf
    v_mov_b32_dpp v192, v192 quad_perm:[0,0,0,0] row_mask:0xf bank_mask:0xf
    v_mov_b32_dpp v200, v200 quad_perm:[0,0,0,0] row_mask:0xf bank_mask:0xf
    v_mov_b32_dpp v208, v208 quad_perm:[0,0,0,0] row_mask:0xf bank_mask:0xf
    v_mov_b32_dpp v216, v216 quad_perm:[0,0,0,0] row_mask:0xf bank_mask:0xf
    v_mov_b32_dpp v224, v224 quad_perm:[0,0,0,0] row_mask:0xf bank_mask:0xf
    v_mov_b32_dpp v232, v232 quad_perm:[0,0,0,0] row_mask:0xf bank_mask:0xf
    v_mov_b32_dpp v240, v240 quad_perm:[0,0,0,0] row_mask:0xf bank_mask:0xf
    v_mov_b32_dpp v248, v248 quad_perm:[0,0,0,0] row_mask:0xf bank_mask:0xf
    v_add_f32_dpp v128, v129, v128 quad_perm:[1,1,1,1] row_mask:0xf bank_mask:0xf
    v_add_f32_dpp v136, v137, v136 quad_perm:[1,1,1,1] row_mask:0xf bank_mask:0xf
    v_add_f32_dpp v144, v145, v144 quad_perm:[1,1,1,1] row_mask:0xf bank_mask:0xf
    v_add_f32_dpp v152, v153, v152 quad_perm:[1,1,1,1] row_mask:0xf bank_mask:0xf
    v_add_f32_dpp v160, v161, v160 quad_perm:[1,1,1,1] row_mask:0xf bank_mask:0xf
    v_add_f32_dpp v168, v169, v168 quad_perm:[1,1,1,1] row_mask:0xf bank_mask:0xf
    v_add_f32_dpp v176, v177, v176 quad_perm:[1,1,1,1] row_mask:0xf bank_mask:0xf
    v_add_f32_dpp v184, v185, v184 quad_perm:[1,1,1,1] row_mask:0xf bank_mask:0xf
    v_add_f32_dpp v192, v193, v192 quad_perm:[1,1,1,1] row_mask:0xf bank_mask:0xf
    v_add_f32_dpp v200, v201, v200 quad_perm:[1,1,1,1] row_mask:0xf bank_mask:0xf
    v_add_f32_dpp v208, v209, v208 quad_perm:[1,1,1,1] row_mask:0xf bank_mask:0xf
    v_add_f32_dpp v216, v217, v216 quad_perm:[1,1,1,1] row_mask:0xf bank_mask:0xf
    v_add_f32_dpp v224, v225, v224 quad_perm:[1,1,1,1] row_mask:0xf bank_mask:0xf
    v_add_f32_dpp v232, v233, v232 quad_perm:[1,1,1,1] row_mask:0xf bank_mask:0xf
    v_add_f32_dpp v240, v241, v240 quad_perm:[1,1,1,1] row_mask:0xf bank_mask:0xf
    v_add_f32_dpp v248, v249, v248 quad_perm:[1,1,1,1] row_mask:0xf bank_mask:0xf
    v_add_f32_dpp v128, v130, v128 quad_perm:[2,2,2,2] row_mask:0xf bank_mask:0xf
    v_add_f32_dpp v136, v138, v136 quad_perm:[2,2,2,2] row_mask:0xf bank_mask:0xf
    v_add_f32_dpp v144, v146, v144 quad_perm:[2,2,2,2] row_mask:0xf bank_mask:0xf
    v_add_f32_dpp v152, v154, v152 quad_perm:[2,2,2,2] row_mask:0xf bank_mask:0xf
    v_add_f32_dpp v160, v162, v160 quad_perm:[2,2,2,2] row_mask:0xf bank_mask:0xf
    v_add_f32_dpp v168, v170, v168 quad_perm:[2,2,2,2] row_mask:0xf bank_mask:0xf
    v_add_f32_dpp v176, v178, v176 quad_perm:[2,2,2,2] row_mask:0xf bank_mask:0xf
    v_add_f32_dpp v184, v186, v184 quad_perm:[2,2,2,2] row_mask:0xf bank_mask:0xf
    v_add_f32_dpp v192, v194, v192 quad_perm:[2,2,2,2] row_mask:0xf bank_mask:0xf
    v_add_f32_dpp v200, v202, v200 quad_perm:[2,2,2,2] row_mask:0xf bank_mask:0xf
    v_add_f32_dpp v208, v210, v208 quad_perm:[2,2,2,2] row_mask:0xf bank_mask:0xf
    v_add_f32_dpp v216, v218, v216 quad_perm:[2,2,2,2] row_mask:0xf bank_mask:0xf
    v_add_f32_dpp v224, v226, v224 quad_perm:[2,2,2,2] row_mask:0xf bank_mask:0xf
    v_add_f32_dpp v232, v234, v232 quad_perm:[2,2,2,2] row_mask:0xf bank_mask:0xf
    v_add_f32_dpp v240, v242, v240 quad_perm:[2,2,2,2] row_mask:0xf bank_mask:0xf
    v_add_f32_dpp v248, v250, v248 quad_perm:[2,2,2,2] row_mask:0xf bank_mask:0xf
    v_add_f32_dpp v128, v131, v128 quad_perm:[3,3,3,3] row_mask:0xf bank_mask:0xf
    v_add_f32_dpp v136, v139, v136 quad_perm:[3,3,3,3] row_mask:0xf bank_mask:0xf
    v_add_f32_dpp v144, v147, v144 quad_perm:[3,3,3,3] row_mask:0xf bank_mask:0xf
    v_add_f32_dpp v152, v155, v152 quad_perm:[3,3,3,3] row_mask:0xf bank_mask:0xf
    v_add_f32_dpp v160, v163, v160 quad_perm:[3,3,3,3] row_mask:0xf bank_mask:0xf
    v_add_f32_dpp v168, v171, v168 quad_perm:[3,3,3,3] row_mask:0xf bank_mask:0xf
    v_add_f32_dpp v176, v179, v176 quad_perm:[3,3,3,3] row_mask:0xf bank_mask:0xf
    v_add_f32_dpp v184, v187, v184 quad_perm:[3,3,3,3] row_mask:0xf bank_mask:0xf
    v_add_f32_dpp v192, v195, v192 quad_perm:[3,3,3,3] row_mask:0xf bank_mask:0xf
    v_add_f32_dpp v200, v203, v200 quad_perm:[3,3,3,3] row_mask:0xf bank_mask:0xf
    v_add_f32_dpp v208, v211, v208 quad_perm:[3,3,3,3] row_mask:0xf bank_mask:0xf
    v_add_f32_dpp v216, v219, v216 quad_perm:[3,3,3,3] row_mask:0xf bank_mask:0xf
    v_add_f32_dpp v224, v227, v224 quad_perm:[3,3,3,3] row_mask:0xf bank_mask:0xf
    v_add_f32_dpp v232, v235, v232 quad_perm:[3,3,3,3] row_mask:0xf bank_mask:0xf
    v_add_f32_dpp v240, v243, v240 quad_perm:[3,3,3,3] row_mask:0xf bank_mask:0xf
    v_add_f32_dpp v248, v251, v248 quad_perm:[3,3,3,3] row_mask:0xf bank_mask:0xf
    v_cvt_pk_bf16_f32 v40, v128, v136
    v_cvt_pk_bf16_f32 v41, v144, v152
    v_cvt_pk_bf16_f32 v42, v160, v168
    v_cvt_pk_bf16_f32 v43, v176, v184
    v_cvt_pk_bf16_f32 v44, v192, v200
    v_cvt_pk_bf16_f32 v45, v208, v216
    v_cvt_pk_bf16_f32 v46, v224, v232
    v_cvt_pk_bf16_f32 v47, v240, v248
    v_lshlrev_b32 v128, 16, v40
    v_and_b32 v136, 0xffff0000, v40
    v_lshlrev_b32 v144, 16, v41
    v_and_b32 v152, 0xffff0000, v41
    v_lshlrev_b32 v160, 16, v42
    v_and_b32 v168, 0xffff0000, v42
    v_lshlrev_b32 v176, 16, v43
    v_and_b32 v184, 0xffff0000, v43
    v_lshlrev_b32 v192, 16, v44
    v_and_b32 v200, 0xffff0000, v44
    v_lshlrev_b32 v208, 16, v45
    v_and_b32 v216, 0xffff0000, v45
    v_lshlrev_b32 v224, 16, v46
    v_and_b32 v232, 0xffff0000, v46
    v_lshlrev_b32 v240, 16, v47
    v_and_b32 v248, 0xffff0000, v47
    v_max3_f32 v6, v128, v136, v144
    v_max3_f32 v7, v152, v160, v168
    v_max3_f32 v8, v176, v184, v192
    v_max3_f32 v9, v200, v208, v216
    v_max3_f32 v10, v224, v232, v240
    v_max3_f32 v6, v6, v7, v248
    v_max3_f32 v8, v8, v9, v10
    v_max_f32 v6, v6, v8
    v_mov_b32 v7, v6
    s_nop 1
    v_permlane16_swap_b32 v6, v7
    v_max_f32 v6, v6, v7
    v_mov_b32 v7, v6
    s_nop 1
    v_permlane32_swap_b32 v6, v7
    v_max_f32 v6, v6, v7
    s_mov_b32 s3, 1035512379
    v_mul_f32 v6, s3, v6
    v_fma_f32 v128, v128, s3, -v6
    v_fma_f32 v136, v136, s3, -v6
    v_fma_f32 v144, v144, s3, -v6
    v_fma_f32 v152, v152, s3, -v6
    v_fma_f32 v160, v160, s3, -v6
    v_fma_f32 v168, v168, s3, -v6
    v_fma_f32 v176, v176, s3, -v6
    v_fma_f32 v184, v184, s3, -v6
    v_fma_f32 v192, v192, s3, -v6
    v_fma_f32 v200, v200, s3, -v6
    v_fma_f32 v208, v208, s3, -v6
    v_fma_f32 v216, v216, s3, -v6
    v_fma_f32 v224, v224, s3, -v6
    v_fma_f32 v232, v232, s3, -v6
    v_fma_f32 v240, v240, s3, -v6
    v_fma_f32 v248, v248, s3, -v6
    v_exp_f32 v128, v128
    v_exp_f32 v136, v136
    v_exp_f32 v144, v144
    v_exp_f32 v152, v152
    v_exp_f32 v160, v160
    v_exp_f32 v168, v168
    v_exp_f32 v176, v176
    v_exp_f32 v184, v184
    v_exp_f32 v192, v192
    v_exp_f32 v200, v200
    v_exp_f32 v208, v208
    v_exp_f32 v216, v216
    v_exp_f32 v224, v224
    v_exp_f32 v232, v232
    v_exp_f32 v240, v240
    v_exp_f32 v248, v248
    v_min_u32 v6, -2, v6
    v_cvt_pk_bf16_f32 v40, v128, v136
    v_cvt_pk_bf16_f32 v41, v144, v152
    v_cvt_pk_bf16_f32 v42, v160, v168
    v_cvt_pk_bf16_f32 v43, v176, v184
    v_cvt_pk_bf16_f32 v44, v192, v200
    v_cvt_pk_bf16_f32 v45, v208, v216
    v_cvt_pk_bf16_f32 v46, v224, v232
    v_cvt_pk_bf16_f32 v47, v240, v248
    v_add_f32 v128, v128, v136
    v_add_f32 v144, v144, v152
    v_add_f32 v160, v160, v168
    v_add_f32 v176, v176, v184
    v_add_f32 v192, v192, v200
    v_add_f32 v208, v208, v216
    v_add_f32 v224, v224, v232
    v_add_f32 v240, v240, v248
    v_add_f32 v128, v128, v144
    v_add_f32 v160, v160, v176
    v_add_f32 v192, v192, v208
    v_add_f32 v224, v224, v240
    v_add_f32 v128, v128, v160
    v_add_f32 v192, v192, v224
    v_add_f32 v7, v128, v192
    v_mov_b32 v8, v7
    s_nop 1
    v_permlane16_swap_b32 v7, v8
    v_add_f32 v7, v7, v8
    v_mov_b32 v8, v7
    s_nop 1
    v_permlane32_swap_b32 v7, v8
    v_add_f32 v7, v7, v8
    s_mov_b64 exec, 0x101
    ds_write_b32 v59, v7 offset:64544
    ds_write_b32 v59, v6 offset:64512
    s_mov_b64 exec, -1
    v_perm_b32 v128, v40, v40, v32
    v_perm_b32 v129, v40, v40, v34
    v_perm_b32 v130, v40, v40, v36
    v_perm_b32 v131, v40, v40, v38
    v_perm_b32 v136, v40, v40, v33
    v_perm_b32 v137, v40, v40, v35
    v_perm_b32 v138, v40, v40, v37
    v_perm_b32 v139, v40, v40, v39
    v_perm_b32 v144, v41, v41, v32
    v_perm_b32 v145, v41, v41, v34
    v_perm_b32 v146, v41, v41, v36
    v_perm_b32 v147, v41, v41, v38
    v_perm_b32 v152, v41, v41, v33
    v_perm_b32 v153, v41, v41, v35
    v_perm_b32 v154, v41, v41, v37
    v_perm_b32 v155, v41, v41, v39
    v_perm_b32 v160, v42, v42, v32
    v_perm_b32 v161, v42, v42, v34
    v_perm_b32 v162, v42, v42, v36
    v_perm_b32 v163, v42, v42, v38
    v_perm_b32 v168, v42, v42, v33
    v_perm_b32 v169, v42, v42, v35
    v_perm_b32 v170, v42, v42, v37
    v_perm_b32 v171, v42, v42, v39
    v_perm_b32 v176, v43, v43, v32
    v_perm_b32 v177, v43, v43, v34
    v_perm_b32 v178, v43, v43, v36
    v_perm_b32 v179, v43, v43, v38
    v_perm_b32 v184, v43, v43, v33
    v_perm_b32 v185, v43, v43, v35
    v_perm_b32 v186, v43, v43, v37
    v_perm_b32 v187, v43, v43, v39
    v_perm_b32 v192, v44, v44, v32
    v_perm_b32 v193, v44, v44, v34
    v_perm_b32 v194, v44, v44, v36
    v_perm_b32 v195, v44, v44, v38
    v_perm_b32 v200, v44, v44, v33
    v_perm_b32 v201, v44, v44, v35
    v_perm_b32 v202, v44, v44, v37
    v_perm_b32 v203, v44, v44, v39
    v_perm_b32 v208, v45, v45, v32
    v_perm_b32 v209, v45, v45, v34
    v_perm_b32 v210, v45, v45, v36
    v_perm_b32 v211, v45, v45, v38
    v_perm_b32 v216, v45, v45, v33
    v_perm_b32 v217, v45, v45, v35
    v_perm_b32 v218, v45, v45, v37
    v_perm_b32 v219, v45, v45, v39
    v_perm_b32 v224, v46, v46, v32
    v_perm_b32 v225, v46, v46, v34
    v_perm_b32 v226, v46, v46, v36
    v_perm_b32 v227, v46, v46, v38
    v_perm_b32 v232, v46, v46, v33
    v_perm_b32 v233, v46, v46, v35
    v_perm_b32 v234, v46, v46, v37
    v_perm_b32 v235, v46, v46, v39
    v_perm_b32 v240, v47, v47, v32
    v_perm_b32 v241, v47, v47, v34
    v_perm_b32 v242, v47, v47, v36
    v_perm_b32 v243, v47, v47, v38
    v_perm_b32 v248, v47, v47, v33
    v_perm_b32 v249, v47, v47, v35
    v_perm_b32 v250, v47, v47, v37
    v_perm_b32 v251, v47, v47, v39
    s_cmp_lt_u32 s54, 4
    s_cbranch_scc1 L_nov2
    s_setprio 1
    buffer_load_dwordx4 v[132:135], v5, s[24:27], s64 offen offset:0 nt
    buffer_load_dwordx4 v[140:143], v5, s[24:27], s64 offen offset:256 nt
    s_nop 0
    buffer_load_dwordx4 v[148:151], v5, s[24:27], s64 offen offset:2048 nt
    buffer_load_dwordx4 v[156:159], v5, s[24:27], s64 offen offset:2304 nt
    s_nop 0
    buffer_load_dwordx4 v[164:167], v5, s[24:27], s65 offen offset:0 nt
    buffer_load_dwordx4 v[172:175], v5, s[24:27], s65 offen offset:256 nt
    s_nop 0
    buffer_load_dwordx4 v[180:183], v5, s[24:27], s65 offen offset:2048 nt
    buffer_load_dwordx4 v[188:191], v5, s[24:27], s65 offen offset:2304 nt
    s_nop 0
    buffer_load_dwordx4 v[196:199], v5, s[24:27], s66 offen offset:0 nt
    buffer_load_dwordx4 v[204:207], v5, s[24:27], s66 offen offset:256 nt
    s_nop 0
    buffer_load_dwordx4 v[212:215], v5, s[24:27], s66 offen offset:2048 nt
    buffer_load_dwordx4 v[220:223], v5, s[24:27], s66 offen offset:2304 nt
    s_nop 0
    buffer_load_dwordx4 v[228:231], v5, s[24:27], s67 offen offset:0 nt
    buffer_load_dwordx4 v[236:239], v5, s[24:27], s67 offen offset:256 nt
    s_nop 0
    buffer_load_dwordx4 v[244:247], v5, s[24:27], s67 offen offset:2048 nt
    buffer_load_dwordx4 v[252:255], v5, s[24:27], s67 offen offset:2304 nt
    s_nop 0
L_nov2:
    s_waitcnt vmcnt(30)
    v_mfma_f32_16x16x32_bf16 v[24:27], v[128:131], v[64:67], 0
    v_mfma_f32_16x16x32_bf16 v[28:31], v[128:131], v[68:71], 0
    s_waitcnt vmcnt(28)
    v_mfma_f32_16x16x32_bf16 v[24:27], v[136:139], v[72:75], v[24:27]
    v_mfma_f32_16x16x32_bf16 v[28:31], v[136:139], v[76:79], v[28:31]
    s_waitcnt vmcnt(26)
    v_mfma_f32_16x16x32_bf16 v[24:27], v[144:147], v[80:83], v[24:27]
    v_mfma_f32_16x16x32_bf16 v[28:31], v[144:147], v[84:87], v[28:31]
    s_waitcnt vmcnt(24)
    v_mfma_f32_16x16x32_bf16 v[24:27], v[152:155], v[88:91], v[24:27]
    v_mfma_f32_16x16x32_bf16 v[28:31], v[152:155], v[92:95], v[28:31]
    s_waitcnt vmcnt(22)
    v_mfma_f32_16x16x32_bf16 v[24:27], v[160:163], v[96:99], v[24:27]
    v_mfma_f32_16x16x32_bf16 v[28:31], v[160:163], v[100:103], v[28:31]
    s_waitcnt vmcnt(20)
    v_mfma_f32_16x16x32_bf16 v[24:27], v[168:171], v[104:107], v[24:27]
    v_mfma_f32_16x16x32_bf16 v[28:31], v[168:171], v[108:111], v[28:31]
    s_waitcnt vmcnt(18)
    v_mfma_f32_16x16x32_bf16 v[24:27], v[176:179], v[112:115], v[24:27]
    v_mfma_f32_16x16x32_bf16 v[28:31], v[176:179], v[116:119], v[28:31]
    s_waitcnt vmcnt(16)
    v_mfma_f32_16x16x32_bf16 v[24:27], v[184:187], v[120:123], v[24:27]
    v_mfma_f32_16x16x32_bf16 v[28:31], v[184:187], v[124:127], v[28:31]
    s_waitcnt vmcnt(14)
    v_mfma_f32_16x16x32_bf16 v[24:27], v[192:195], v[132:135], v[24:27]
    v_mfma_f32_16x16x32_bf16 v[28:31], v[192:195], v[140:143], v[28:31]
    s_waitcnt vmcnt(12)
    v_mfma_f32_16x16x32_bf16 v[24:27], v[200:203], v[148:151], v[24:27]
    v_mfma_f32_16x16x32_bf16 v[28:31], v[200:203], v[156:159], v[28:31]
    s_waitcnt vmcnt(10)
    v_mfma_f32_16x16x32_bf16 v[24:27], v[208:211], v[164:167], v[24:27]
    v_mfma_f32_16x16x32_bf16 v[28:31], v[208:211], v[172:175], v[28:31]
    s_waitcnt vmcnt(8)
    v_mfma_f32_16x16x32_bf16 v[24:27], v[216:219], v[180:183], v[24:27]
    v_mfma_f32_16x16x32_bf16 v[28:31], v[216:219], v[188:191], v[28:31]
    s_waitcnt vmcnt(6)
    v_mfma_f32_16x16x32_bf16 v[24:27], v[224:227], v[196:199], v[24:27]
    v_mfma_f32_16x16x32_bf16 v[28:31], v[224:227], v[204:207], v[28:31]
    s_waitcnt vmcnt(4)
    v_mfma_f32_16x16x32_bf16 v[24:27], v[232:235], v[212:215], v[24:27]
    v_mfma_f32_16x16x32_bf16 v[28:31], v[232:235], v[220:223], v[28:31]
    s_waitcnt vmcnt(2)
    v_mfma_f32_16x16x32_bf16 v[24:27], v[240:243], v[228:231], v[24:27]
    v_mfma_f32_16x16x32_bf16 v[28:31], v[240:243], v[236:239], v[28:31]
    s_waitcnt vmcnt(0)
    v_mfma_f32_16x16x32_bf16 v[24:27], v[248:251], v[244:247], v[24:27]
    v_mfma_f32_16x16x32_bf16 v[28:31], v[248:251], v[252:255], v[28:31]
    s_nop 7
    ds_write_b128 v48, v[24:27] offset:0
    ds_write_b128 v48, v[28:31] offset:512
    s_cmp_ge_u32 s54, 4
    s_cbranch_scc1 L_barA
    s_cmp_eq_u32 s75, 7
    s_cbranch_scc1 L_nowo
    buffer_load_dwordx4 v55, s[32:35], s80 offen offset:0 nt lds
    buffer_load_dwordx4 v55, s[32:35], s81 offen offset:1024 nt lds
    buffer_load_dwordx4 v55, s[32:35], s82 offen offset:2048 nt lds
    buffer_load_dwordx4 v55, s[32:35], s83 offen offset:3072 nt lds
    s_add_u32 m0, m0, 4096
    s_nop 0
    buffer_load_dwordx4 v55, s[32:35], s84 offen offset:0 nt lds
    buffer_load_dwordx4 v55, s[32:35], s85 offen offset:1024 nt lds
    buffer_load_dwordx4 v55, s[32:35], s86 offen offset:2048 nt lds
    buffer_load_dwordx4 v55, s[32:35], s87 offen offset:3072 nt lds
L_nowo:
    v_xor_b32 v8, 16, v57
L_ml:
    ds_read_b128 v[64:67], v57 offset:64512
    ds_read_b128 v[68:71], v8 offset:64512
    ds_read_b128 v[72:75], v57 offset:64544
    s_waitcnt lgkmcnt(0)
    v_max3_u32 v6, v64, v65, v66
    v_max3_u32 v7, v67, v68, v69
    v_max3_u32 v6, v6, v70, v71
    v_max_u32 v6, v6, v7
    v_cmp_ne_u32 vcc, -1, v6
    s_cmp_eq_u64 vcc, -1
    s_cbranch_scc1 L_ml_ok
    s_sleep 1
    s_sub_u32 s70, s70, 1
    s_cmp_gt_i32 s70, 0
    s_cbranch_scc1 L_ml
L_ml_ok:
    v_max3_f32 v116, v64, v65, v66
    v_max3_f32 v7, v67, v68, v69
    v_max3_f32 v116, v116, v70, v71
    v_max_f32 v116, v116, v7
    v_sub_f32 v64, v64, v116
    v_sub_f32 v65, v65, v116
    v_sub_f32 v66, v66, v116
    v_sub_f32 v67, v67, v116
    v_exp_f32 v64, v64
    v_exp_f32 v65, v65
    v_exp_f32 v66, v66
    v_exp_f32 v67, v67
    v_mov_b32 v114, s52
    v_mov_b32 v115, s53
    v_mov_b32 v118, s52
    v_mov_b32 v119, s53
    v_mul_f32 v117, v64, v72
    v_fmac_f32 v117, v65, v73
    v_fmac_f32 v117, v66, v74
    v_fmac_f32 v117, v67, v75
    v_mov_b32 v7, v117
    s_nop 1
    v_permlane32_swap_b32 v117, v7
    v_add_f32 v117, v117, v7
    s_mov_b64 exec, 1
    s_cmp_eq_u32 s99, 1
    s_cbranch_scc1 L_pml_loc
    buffer_store_dwordx4 v[116:119], v12, s[28:31], s74 offen sc1
    s_branch L_pml_done
L_pml_loc:
    buffer_store_dwordx4 v[116:119], v12, s[28:31], s74 offen
L_pml_done:
    s_mov_b64 exec, -1
L_barA:
    s_waitcnt lgkmcnt(0)
    s_barrier
    s_cmp_ge_u32 s54, 4
    s_cbranch_scc1 L_gather
    ds_read_b128 v[80:83], v54 offset:0
    ds_read_b128 v[84:87], v54 offset:2048
    ds_read_b128 v[88:91], v54 offset:4096
    ds_read_b128 v[92:95], v54 offset:6144
    s_waitcnt lgkmcnt(3)
    v_mul_f32 v120, v64, v80
    v_mul_f32 v121, v64, v81
    v_mul_f32 v122, v64, v82
    v_mul_f32 v123, v64, v83
    s_waitcnt lgkmcnt(2)
    v_fmac_f32 v120, v65, v84
    v_fmac_f32 v122, v65, v86
    v_fmac_f32 v121, v65, v85
    v_fmac_f32 v123, v65, v87
    s_waitcnt lgkmcnt(1)
    v_fmac_f32 v120, v66, v88
    v_fmac_f32 v122, v66, v90
    v_fmac_f32 v121, v66, v89
    v_fmac_f32 v123, v66, v91
    s_waitcnt lgkmcnt(0)
    v_fmac_f32 v120, v67, v92
    v_fmac_f32 v122, v67, v94
    v_fmac_f32 v121, v67, v93
    v_fmac_f32 v123, v67, v95
    s_nop 0
    v_permlane32_swap_b32 v120, v122
    v_permlane32_swap_b32 v121, v123
    v_add_f32 v120, v120, v122
    v_add_f32 v121, v121, v123
    v_cvt_pk_bf16_f32 v112, v120, v121
    v_mov_b32 v113, v112
    s_nop 1
    v_permlane32_swap_b32 v112, v113
    s_mov_b32 exec_hi, 0
    s_cmp_eq_u32 s99, 1
    s_cbranch_scc1 L_po_loc
    buffer_store_dwordx4 v[112:115], v56, s[28:31], s72 offen sc1
    s_branch L_po_done
L_po_loc:
    buffer_store_dwordx4 v[112:115], v56, s[28:31], s72 offen
L_po_done:
    s_mov_b64 exec, -1
    s_waitcnt vmcnt(2)
    s_branch L_gather2
L_gather:
    s_cmp_lg_u32 s54, 7
    s_cbranch_scc1 L_gather2
    s_cmp_eq_u32 s89, 0
    s_cbranch_scc1 L_gather2
    s_mul_i32 s59, s75, 896
    s_add_u32 s36, s36, s59
    s_addc_u32 s37, s37, 0
    s_mov_b32 s38, 896
    s_mov_b32 s39, 0x20000
    s_mov_b32 s40, s48
    s_mov_b32 s41, s49
    s_mov_b32 s42, 896
    s_mov_b32 s43, 0x20000
    buffer_load_dwordx4 v[16:19], v12, s[36:39], 0 offen
    buffer_load_dwordx4 v[20:23], v12, s[40:43], 0 offen
L_gather2:
    s_cmp_eq_u32 s75, 7
    s_cbranch_scc1 L_final
    s_barrier
    v_mov_b32 v72, 0
    v_mov_b32 v73, 0
    v_mov_b32 v74, s52
    v_mov_b32 v75, s53
    buffer_load_dwordx4 v[64:67], v49, s[28:31], s90 offen sc1
    buffer_load_dwordx4 v[68:71], v49, s[28:31], s90 offen offset:1024 sc1
    s_cmp_ge_u32 s54, 4
    s_cbranch_scc1 L_h1noml
    buffer_load_dwordx4 v[72:75], v60, s[28:31], s91 offen sc1
    ds_read_b64_tr_b16 v[128:129], v52 offset:0
    ds_read_b64_tr_b16 v[130:131], v52 offset:2048
    ds_read_b64_tr_b16 v[132:133], v52 offset:4096
    ds_read_b64_tr_b16 v[134:135], v52 offset:6144
    ds_read_b64_tr_b16 v[136:137], v52 offset:8192
    ds_read_b64_tr_b16 v[138:139], v52 offset:10240
    ds_read_b64_tr_b16 v[140:141], v52 offset:12288
    ds_read_b64_tr_b16 v[142:143], v52 offset:14336
    ds_read_b64_tr_b16 v[144:145], v52 offset:16384
    ds_read_b64_tr_b16 v[146:147], v52 offset:18432
    ds_read_b64_tr_b16 v[148:149], v52 offset:20480
    ds_read_b64_tr_b16 v[150:151], v52 offset:22528
    ds_read_b64_tr_b16 v[152:153], v52 offset:24576
    ds_read_b64_tr_b16 v[154:155], v52 offset:26624
    ds_read_b64_tr_b16 v[156:157], v52 offset:28672
    ds_read_b64_tr_b16 v[158:159], v52 offset:30720
    s_branch L_h1noml
L_h1poll:
    buffer_load_dwordx4 v[64:67], v49, s[28:31], s90 offen sc1
    buffer_load_dwordx4 v[68:71], v49, s[28:31], s90 offen offset:1024 sc1
    s_cmp_ge_u32 s54, 4
    s_cbranch_scc1 L_h1noml
    buffer_load_dwordx4 v[72:75], v60, s[28:31], s91 offen sc1
L_h1noml:
    s_waitcnt vmcnt(0)
    v_cmp_eq_u64 vcc, s[52:53], v[66:67]
    v_cmp_eq_u64 s[68:69], s[52:53], v[70:71]
    v_cmp_eq_u64 s[94:95], s[52:53], v[74:75]
    s_nop 0
    s_and_b64 vcc, vcc, s[68:69]
    s_and_b64 vcc, vcc, s[94:95]
    s_andn2_b64 exec, exec, vcc
    s_cbranch_execz L_h1poll_ok
    s_sleep 1
    s_sub_u32 s70, s70, 1
    s_cmp_gt_i32 s70, 0
    s_cbranch_scc1 L_h1poll
L_h1poll_ok:
    s_mov_b64 exec, -1
    v_mov_b32 v66, v68
    v_mov_b32 v67, v69
    ds_write_b128 v53, v[64:67] offset:28672
    v_mov_b32_dpp v74, v72 row_ror:8 row_mask:0xf bank_mask:0xf
    v_mov_b32_dpp v75, v73 row_ror:8 row_mask:0xf bank_mask:0xf
    v_max_f32 v69, v74, v72
    v_sub_f32 v74, v74, v69
    v_sub_f32 v72, v72, v69
    v_exp_f32 v74, v74
    v_exp_f32 v72, v72
    v_mov_b32 v98, s52
    v_mul_f32 v75, v75, v74
    v_fmac_f32 v75, v73, v72
    v_rcp_f32 v75, v75
    v_mov_b32 v99, s53
    v_mul_f32 v112, v72, v75
    s_waitcnt lgkmcnt(0)
    s_barrier
    s_cmp_ge_u32 s54, 4
    s_cbranch_scc1 L_final
    ds_read_b128 v[64:67], v12 offset:28672
    ds_read_b128 v[68:71], v12 offset:29696
    ds_read_b128 v[72:75], v12 offset:30720
    ds_read_b128 v[76:79], v12 offset:31744
    ds_read_b128 v[80:83], v12 offset:32768
    ds_read_b128 v[84:87], v12 offset:33792
    ds_read_b128 v[88:91], v12 offset:34816
    ds_read_b128 v[92:95], v12 offset:35840
    s_waitcnt lgkmcnt(7)
    v_mfma_f32_16x16x32_bf16 v[104:107], v[128:131], v[64:67], 0
    s_waitcnt lgkmcnt(6)
    v_mfma_f32_16x16x32_bf16 v[100:103], v[132:135], v[68:71], 0
    s_waitcnt lgkmcnt(5)
    v_mfma_f32_16x16x32_bf16 v[104:107], v[136:139], v[72:75], v[104:107]
    s_waitcnt lgkmcnt(4)
    v_mfma_f32_16x16x32_bf16 v[100:103], v[140:143], v[76:79], v[100:103]
    s_waitcnt lgkmcnt(3)
    v_mfma_f32_16x16x32_bf16 v[104:107], v[144:147], v[80:83], v[104:107]
    s_waitcnt lgkmcnt(2)
    v_mfma_f32_16x16x32_bf16 v[100:103], v[148:151], v[84:87], v[100:103]
    s_waitcnt lgkmcnt(1)
    v_mfma_f32_16x16x32_bf16 v[104:107], v[152:155], v[88:91], v[104:107]
    s_waitcnt lgkmcnt(0)
    v_mfma_f32_16x16x32_bf16 v[100:103], v[156:159], v[92:95], v[100:103]
    s_nop 7
    v_add_f32 v100, v100, v104
    v_add_f32 v101, v101, v105
    v_add_f32 v102, v102, v106
    v_add_f32 v103, v103, v107
    v_mul_f32 v100, v100, v112
    v_mul_f32 v101, v101, v112
    v_mul_f32 v102, v102, v112
    v_mul_f32 v103, v103, v112
    v_add_f32_dpp v96, v100, v100 row_ror:8 row_mask:0xf bank_mask:0x3
    v_add_f32_dpp v97, v101, v101 row_ror:8 row_mask:0xf bank_mask:0x3
    s_nop 0
    v_add_f32_dpp v96, v102, v102 row_ror:8 row_mask:0xf bank_mask:0xc
    v_add_f32_dpp v97, v103, v103 row_ror:8 row_mask:0xf bank_mask:0xc
    buffer_store_dwordx4 v[96:99], v58, s[28:31], s73 offen sc1
L_final:
    s_cmp_eq_u32 s89, 0
    s_cbranch_scc1 L_done
    s_lshl_b32 s3, s55, 17
    s_lshl_b32 s59, s75, 14
    s_add_u32 s3, s3, s59
    s_lshl_b32 s59, s71, 13
    s_add_u32 s3, s3, s59
    s_lshl_b32 s59, s54, 10
    s_add_u32 s3, s3, s59
    s_add_u32 s3, s3, 1114112
    v_lshlrev_b32 v13, 3, v0
    s_mov_b32 s44, s50
    s_mov_b32 s45, s51
    s_mov_b32 s46, 7168
    s_mov_b32 s47, 0x20000
    s_mul_i32 s59, s75, 896
    s_lshl_b32 s78, s55, 7
    s_add_u32 s78, s78, s59
    s_lshl_b32 s59, s71, 6
    s_add_u32 s78, s78, s59
    v_lshrrev_b32 v14, 3, v1
    v_lshlrev_b32 v14, 9, v14
    v_and_b32 v11, 7, v1
    v_lshl_add_u32 v14, v11, 4, v14
    v_lshlrev_b32 v11, 3, v11
    v_lshl_add_u32 v11, v3, 2, v11
    s_cmp_lg_u32 s54, 7
    s_cbranch_scc1 L_nogate
    s_waitcnt vmcnt(0)
    v_lshlrev_b32 v136, 16, v16
    v_and_b32 v137, 0xffff0000, v16
    v_lshlrev_b32 v144, 16, v20
    v_and_b32 v145, 0xffff0000, v20
    v_lshlrev_b32 v138, 16, v17
    v_and_b32 v139, 0xffff0000, v17
    v_lshlrev_b32 v146, 16, v21
    v_and_b32 v147, 0xffff0000, v21
    v_lshlrev_b32 v140, 16, v18
    v_and_b32 v141, 0xffff0000, v18
    v_lshlrev_b32 v148, 16, v22
    v_and_b32 v149, 0xffff0000, v22
    v_lshlrev_b32 v142, 16, v19
    v_and_b32 v143, 0xffff0000, v19
    v_lshlrev_b32 v150, 16, v23
    v_and_b32 v151, 0xffff0000, v23
    v_mul_f32 v136, v136, v144
    v_mul_f32 v137, v137, v145
    v_mul_f32 v138, v138, v146
    v_mul_f32 v139, v139, v147
    v_mul_f32 v140, v140, v148
    v_mul_f32 v141, v141, v149
    v_mul_f32 v142, v142, v150
    v_mul_f32 v143, v143, v151
    v_cvt_pk_bf16_f32 v128, v136, v137
    v_cvt_pk_bf16_f32 v129, v138, v139
    v_cvt_pk_bf16_f32 v130, v140, v141
    v_cvt_pk_bf16_f32 v131, v142, v143
    v_lshlrev_b32 v136, 16, v128
    v_and_b32 v137, 0xffff0000, v128
    v_lshlrev_b32 v138, 16, v129
    v_and_b32 v139, 0xffff0000, v129
    v_lshlrev_b32 v140, 16, v130
    v_and_b32 v141, 0xffff0000, v130
    v_lshlrev_b32 v142, 16, v131
    v_and_b32 v143, 0xffff0000, v131
    v_add_f32 v136, v136, v140
    v_add_f32 v137, v137, v141
    v_add_f32 v138, v138, v142
    v_add_f32 v139, v139, v143
    v_add_f32 v136, v136, v138
    v_add_f32 v137, v137, v139
    v_add_f32 v62, v136, v137
    s_nop 1
    v_add_f32_dpp v62, v62, v62 row_ror:8 row_mask:0xf bank_mask:0xf
    s_nop 1
    v_add_f32_dpp v62, v62, v62 row_ror:4 row_mask:0xf bank_mask:0xf
    s_nop 1
    v_add_f32_dpp v62, v62, v62 row_ror:2 row_mask:0xf bank_mask:0xf
    s_nop 1
    v_add_f32_dpp v62, v62, v62 row_ror:1 row_mask:0xf bank_mask:0xf
    v_mov_b32 v63, v62
    s_nop 1
    v_permlane16_swap_b32 v62, v63
    v_add_f32 v62, v62, v63
    v_mov_b32 v63, v62
    s_nop 1
    v_permlane32_swap_b32 v62, v63
    v_add_f32 v62, v62, v63
    v_cvt_pk_bf16_f32 v62, v62, v62
    v_lshlrev_b32 v62, 16, v62
    v_mul_f32 v62, 0xbfb8aa3b, v62
    v_exp_f32 v62, v62
    s_nop 0
    v_add_f32 v62, 1.0, v62
    v_rcp_f32 v62, v62
    s_nop 0
    v_cvt_pk_bf16_f32 v62, v62, v62
    v_lshlrev_b32 v62, 16, v62
    v_sub_f32 v63, 1.0, v62
    v_cvt_pk_bf16_f32 v63, v63, v63
    v_lshlrev_b32 v63, 16, v63
    s_branch L_h2poll
L_nogate:
    s_sleep 16
L_h2poll:
    buffer_load_dwordx4 v[80:83], v12, s[28:31], s3 offen sc1
    s_sleep 8
    buffer_load_dwordx4 v[84:87], v12, s[28:31], s3 offen sc1
L_h2p:
    s_waitcnt vmcnt(1)
    v_cmp_eq_u64 vcc, s[52:53], v[82:83]
    s_andn2_b64 s[92:93], exec, vcc
    s_mov_b64 exec, vcc
    v_mov_b32 v68, v80
    v_mov_b32 v69, v81
    s_mov_b64 exec, s[92:93]
    s_cbranch_execz L_h2p_ok
    buffer_load_dwordx4 v[80:83], v12, s[28:31], s3 offen sc1
    s_waitcnt vmcnt(1)
    v_cmp_eq_u64 vcc, s[52:53], v[86:87]
    s_andn2_b64 s[92:93], exec, vcc
    s_mov_b64 exec, vcc
    v_mov_b32 v68, v84
    v_mov_b32 v69, v85
    s_mov_b64 exec, s[92:93]
    s_cbranch_execz L_h2p_ok
    buffer_load_dwordx4 v[84:87], v12, s[28:31], s3 offen sc1
    s_sub_u32 s70, s70, 1
    s_cmp_gt_i32 s70, 0
    s_cbranch_scc1 L_h2p
L_h2p_ok:
    s_mov_b64 exec, -1
    ds_write_b64 v13, v[68:69] offset:16384
    s_waitcnt lgkmcnt(0)
    s_barrier
    s_cmp_lg_u32 s54, 7
    s_cbranch_scc1 L_done
    ds_read_b128 v[64:67], v14 offset:16384
    ds_read_b128 v[68:71], v14 offset:16512
    ds_read_b128 v[72:75], v14 offset:16640
    ds_read_b128 v[76:79], v14 offset:16768
    s_waitcnt lgkmcnt(2)
    v_add_f32 v64, v64, v68
    v_add_f32 v65, v65, v69
    v_add_f32 v66, v66, v70
    v_add_f32 v67, v67, v71
    s_waitcnt lgkmcnt(0)
    v_add_f32 v72, v72, v76
    v_add_f32 v73, v73, v77
    v_add_f32 v74, v74, v78
    v_add_f32 v75, v75, v79
    v_add_f32 v64, v64, v72
    v_add_f32 v65, v65, v73
    v_add_f32 v66, v66, v74
    v_add_f32 v67, v67, v75
    s_nop 1
    v_permlane16_swap_b32 v64, v66
    v_permlane16_swap_b32 v65, v67
    v_add_f32 v64, v64, v66
    v_add_f32 v65, v65, v67
    s_nop 0
    v_add_f32_dpp v64, v64, v64 row_ror:8 row_mask:0xf bank_mask:0xf
    v_add_f32_dpp v65, v65, v65 row_ror:8 row_mask:0xf bank_mask:0xf
    v_cvt_pk_bf16_f32 v64, v64, v65
    v_mov_b32 v66, v64
    s_nop 1
    v_permlane32_swap_b32 v64, v66
    v_lshlrev_b32 v68, 16, v64
    v_and_b32 v69, 0xffff0000, v64
    v_lshlrev_b32 v70, 16, v66
    v_and_b32 v71, 0xffff0000, v66
    v_mul_f32 v68, v62, v68
    v_mul_f32 v69, v62, v69
    v_mul_f32 v70, v63, v70
    v_mul_f32 v71, v63, v71
    v_cvt_pk_bf16_f32 v64, v68, v69
    v_cvt_pk_bf16_f32 v66, v70, v71
    v_lshlrev_b32 v68, 16, v64
    v_and_b32 v69, 0xffff0000, v64
    v_lshlrev_b32 v70, 16, v66
    v_and_b32 v71, 0xffff0000, v66
    v_add_f32 v68, v68, v70
    v_add_f32 v69, v69, v71
    v_cvt_pk_bf16_f32 v64, v68, v69
    s_mov_b64 exec, 0x00ff00ff
    buffer_store_dword v64, v11, s[44:47], s78 offen
    s_cmp_lg_u32 s2, 0
    s_cbranch_scc1 L_done
    s_mov_b64 exec, 1
    v_mov_b32 v66, s52
    v_mov_b32 v67, s53
    s_mov_b32 s3, 2031616
    buffer_store_dwordx2 v[66:67], v11, s[28:31], s3 offen sc1
L_done:
L_end:
    s_endpgm
.section .rodata,"a"
.p2align 6
.amdhsa_kernel gated_mix__sliding_block_cached__sliding_block_cached__decode_kernel
  .amdhsa_next_free_vgpr 256
  .amdhsa_next_free_sgpr 102
  .amdhsa_accum_offset 256
  .amdhsa_group_segment_fixed_size 0
  .amdhsa_kernarg_size 112
  .amdhsa_user_sgpr_count 2
  .amdhsa_user_sgpr_kernarg_segment_ptr 1
  .amdhsa_system_sgpr_workgroup_id_x 1
  .amdhsa_float_denorm_mode_32 3
.end_amdhsa_kernel
```
